```python
import torch

def _softmax(x, axis=-1):
    return torch.softmax(x, dim=axis)
def _gelu(x):
    return torch.nn.functional.gelu(x, approximate="tanh")
def _silu(x):
    return torch.nn.functional.silu(x)
def _sigmoid(x):
    return torch.sigmoid(x)
def _layernorm(x, axis=-1, eps=1e-5):
    m = x.mean(dim=axis, keepdim=True)
    v = x.var(dim=axis, keepdim=True, unbiased=False)
    return (x - m) / torch.sqrt(v + eps)
def _scatter_add(tgt, idx, src, axis=0):
    return tgt.clone().index_add_(axis, idx, src)
def _segment_sum(src, seg, n):
    out = torch.zeros((n,) + src.shape[1:], dtype=src.dtype)
    return out.index_add_(0, seg, src)
def _pad(x, pw):
    flat = tuple(v for pair in reversed(pw) for v in pair)
    return torch.nn.functional.pad(x, flat)

kernel_name = 'recurrent_scan__spectral_gfnet__swiglu_ffn__prompt'

def setup_inputs():

    _w = (lambda a: (lambda t: t.to(torch.bfloat16) if t.is_floating_point() else t)(torch.as_tensor(a)))
    def _A_setup():
        B, S, D = 1, 2048, 512
        Df = D // 2 + 1
        return {
            "x": _w((lambda *s: torch.randn(*s, dtype=torch.bfloat16) * 0.05)(B, S, D)),
            "w_r": _w((lambda *s: torch.randn(*s, dtype=torch.bfloat16) * 0.1)(S, Df) * 0.02),
            "w_i": _w((lambda *s: torch.randn(*s, dtype=torch.bfloat16) * 0.1)(S, Df) * 0.02),
        }
    _A_in = _A_setup()

    def _B_setup():
        B, S, D, F = 1, 2048, 512, 1792
        return {
            "x": _w((lambda *s: torch.randn(*s, dtype=torch.bfloat16) * 0.05)(B, S, D)),
            "w_gate": _w((lambda *s: torch.randn(*s, dtype=torch.bfloat16) * 0.05)(D, F)),
            "w_up": _w((lambda *s: torch.randn(*s, dtype=torch.bfloat16) * 0.05)(D, F)),
            "w_down": _w((lambda *s: torch.randn(*s, dtype=torch.bfloat16) * 0.05)(F, D)),
        }
    _B_in = _B_setup()

    return {
        "A_x": _A_in["x"],
        "A_w_r": _A_in["w_r"],
        "A_w_i": _A_in["w_i"],
        "B_x": _B_in["x"],
        "B_w_gate": _B_in["w_gate"],
        "B_w_up": _B_in["w_up"],
        "B_w_down": _B_in["w_down"],
    }

def reference(A_x, A_w_r, A_w_i, B_x, B_w_gate, B_w_up, B_w_down):
    def _A_ref(x, w_r, w_i):
        B, S, D = x.shape
        X = (lambda x, axes=(-2,-1): torch.fft.rfft2(x.float(), dim=axes))(x, axes=(-2, -1))
        W = w_r + 1j * w_i
        X = X * W
        y = (lambda x, s, axes=(-2,-1): torch.fft.irfft2(x, s=s, dim=axes).to(torch.bfloat16))(X, (S, D), axes=(-2, -1))
        return y

    def _B_ref(x, w_gate, w_up, w_down):
        g = _silu(x @ w_gate)
        u = x @ w_up
        return (g * u) @ w_down

    x = A_x
    xn = _layernorm(x, axis=-1)
    s = _A_ref(xn, A_w_r, A_w_i)
    g = _silu(_B_ref(xn, B_w_gate, B_w_up, B_w_down))
    return x + s * g
```

```asm
; @launch kernel=rows_kernel grid=(256,1,1) block=(256,1,1) lds=20480
; @launch kernel=gemm1_kernel grid=(256,1,1) block=(256,1,1) lds=147456
; @launch kernel=gemm2_kernel grid=(513,1,1) block=(256,1,1) lds=65536
; @launch kernel=final_kernel grid=(256,1,1) block=(256,1,1) lds=20480
.amdgcn_target "amdgcn-amd-amdhsa--gfx950"
.text
.globl rows_kernel
.p2align 8
.type rows_kernel,@function
rows_kernel:
    s_cmp_ge_u32 s2, 256
    s_cbranch_scc1 L_rows_done
    s_cmp_ge_u32 s2, 256
    s_cbranch_scc1 L_rows_wdt
    s_load_dwordx2 s[4:5], s[0:1], 0
    s_load_dwordx2 s[6:7], s[0:1], 8
    s_load_dwordx2 s[8:9], s[0:1], 16
    s_load_dwordx2 s[10:11], s[0:1], 72
    v_and_b32 v1, 63, v0
    v_lshrrev_b32 v2, 6, v0
    s_lshl_b32 s40, s2, 3
    v_lshlrev_b32 v3, 1, v2
    v_add_u32 v3, s40, v3
    v_lshlrev_b32 v4, 10, v3
    v_lshl_add_u32 v4, v1, 1, v4
    v_mul_u32_u24 v5, 0x202, v3
    v_lshl_add_u32 v5, v1, 1, v5
    s_mov_b32 s36, 0x3f3504f3
    s_waitcnt lgkmcnt(0)
    s_mov_b32 s12, s4
    s_mov_b32 s13, s5
    s_mov_b32 s14, 0x200000
    s_mov_b32 s15, 0x00020000
    s_mov_b32 s16, s6
    s_mov_b32 s17, s7
    s_mov_b32 s18, 0x101000
    s_mov_b32 s19, 0x00020000
    s_mov_b32 s20, s8
    s_mov_b32 s21, s9
    s_mov_b32 s22, 0x101000
    s_mov_b32 s23, 0x00020000
    s_mov_b32 s24, s10
    s_mov_b32 s25, s11
    s_mov_b32 s26, 0x404000
    s_mov_b32 s27, 0x00020000
    s_add_u32 s28, s10, 0x500000
    s_addc_u32 s29, s11, 0
    s_mov_b32 s30, 0x202000
    s_mov_b32 s31, 0x00020000
    s_add_u32 s32, s10, 0x800000
    s_addc_u32 s33, s11, 0
    s_mov_b32 s34, 0x200000
    s_mov_b32 s35, 0x00020000
    buffer_load_ushort v8, v4, s[12:15], 0 offen offset:0
    buffer_load_ushort v9, v4, s[12:15], 0 offen offset:1024
    buffer_load_ushort v10, v4, s[12:15], 0 offen offset:128
    buffer_load_ushort v11, v4, s[12:15], 0 offen offset:1152
    buffer_load_ushort v12, v4, s[12:15], 0 offen offset:256
    buffer_load_ushort v13, v4, s[12:15], 0 offen offset:1280
    buffer_load_ushort v14, v4, s[12:15], 0 offen offset:384
    buffer_load_ushort v15, v4, s[12:15], 0 offen offset:1408
    buffer_load_ushort v16, v4, s[12:15], 0 offen offset:512
    buffer_load_ushort v17, v4, s[12:15], 0 offen offset:1536
    buffer_load_ushort v18, v4, s[12:15], 0 offen offset:640
    buffer_load_ushort v19, v4, s[12:15], 0 offen offset:1664
    buffer_load_ushort v20, v4, s[12:15], 0 offen offset:768
    buffer_load_ushort v21, v4, s[12:15], 0 offen offset:1792
    buffer_load_ushort v22, v4, s[12:15], 0 offen offset:896
    buffer_load_ushort v23, v4, s[12:15], 0 offen offset:1920
    v_lshrrev_b32 v100, 3, v1
    v_cvt_f32_u32 v100, v100
    v_mul_f32 v100, 0xbc800000, v100
    v_mul_f32 v101, 0x3f800000, v100
    v_cos_f32 v70, v101
    v_sin_f32 v71, v101
    v_mul_f32 v101, 0x40000000, v100
    v_cos_f32 v72, v101
    v_sin_f32 v73, v101
    v_mul_f32 v101, 0x40400000, v100
    v_cos_f32 v74, v101
    v_sin_f32 v75, v101
    v_mul_f32 v101, 0x40800000, v100
    v_cos_f32 v76, v101
    v_sin_f32 v77, v101
    v_mul_f32 v101, 0x40a00000, v100
    v_cos_f32 v78, v101
    v_sin_f32 v79, v101
    v_mul_f32 v101, 0x40c00000, v100
    v_cos_f32 v80, v101
    v_sin_f32 v81, v101
    v_mul_f32 v101, 0x40e00000, v100
    v_cos_f32 v82, v101
    v_sin_f32 v83, v101
    v_and_b32 v100, 7, v1
    v_lshrrev_b32 v101, 3, v1
    v_mul_u32_u24 v102, v100, v101
    v_cvt_f32_u32 v102, v102
    v_cvt_f32_u32 v100, v100
    v_mul_f32 v102, 0xbb000000, v102
    v_mul_f32 v100, 0xbc800000, v100
    v_mov_b32 v103, 0x0
    v_fma_f32 v101, v100, v103, v102
    v_cos_f32 v84, v101
    v_sin_f32 v85, v101
    v_mov_b32 v103, 0x3f800000
    v_fma_f32 v101, v100, v103, v102
    v_cos_f32 v86, v101
    v_sin_f32 v87, v101
    v_mov_b32 v103, 0x40000000
    v_fma_f32 v101, v100, v103, v102
    v_cos_f32 v88, v101
    v_sin_f32 v89, v101
    v_mov_b32 v103, 0x40400000
    v_fma_f32 v101, v100, v103, v102
    v_cos_f32 v90, v101
    v_sin_f32 v91, v101
    v_mov_b32 v103, 0x40800000
    v_fma_f32 v101, v100, v103, v102
    v_cos_f32 v92, v101
    v_sin_f32 v93, v101
    v_mov_b32 v103, 0x40a00000
    v_fma_f32 v101, v100, v103, v102
    v_cos_f32 v94, v101
    v_sin_f32 v95, v101
    v_mov_b32 v103, 0x40c00000
    v_fma_f32 v101, v100, v103, v102
    v_cos_f32 v96, v101
    v_sin_f32 v97, v101
    v_mov_b32 v103, 0x40e00000
    v_fma_f32 v101, v100, v103, v102
    v_cos_f32 v98, v101
    v_sin_f32 v99, v101
    v_mul_u32_u24 v125, 5120, v2
    v_lshl_add_u32 v120, v1, 3, v125
    v_lshrrev_b32 v126, 3, v1
    v_and_b32 v127, 7, v1
    v_mul_u32_u24 v128, 72, v126
    v_add_u32 v128, v128, v127
    v_lshl_add_u32 v121, v128, 3, v125
    v_mul_u32_u24 v128, 9, v126
    v_add_u32 v128, v128, v127
    v_lshl_add_u32 v122, v128, 3, v125
    v_mul_u32_u24 v128, 72, v126
    v_mul_u32_u24 v129, 9, v127
    v_add_u32 v128, v128, v129
    v_lshl_add_u32 v123, v128, 3, v125
    v_sub_u32 v128, 64, v1
    v_lshl_add_u32 v124, v128, 3, v125
    s_waitcnt vmcnt(0)
    v_lshlrev_b32 v8, 16, v8
    v_lshlrev_b32 v9, 16, v9
    v_lshlrev_b32 v10, 16, v10
    v_lshlrev_b32 v11, 16, v11
    v_lshlrev_b32 v12, 16, v12
    v_lshlrev_b32 v13, 16, v13
    v_lshlrev_b32 v14, 16, v14
    v_lshlrev_b32 v15, 16, v15
    v_lshlrev_b32 v16, 16, v16
    v_lshlrev_b32 v17, 16, v17
    v_lshlrev_b32 v18, 16, v18
    v_lshlrev_b32 v19, 16, v19
    v_lshlrev_b32 v20, 16, v20
    v_lshlrev_b32 v21, 16, v21
    v_lshlrev_b32 v22, 16, v22
    v_lshlrev_b32 v23, 16, v23
    v_add_f32 v100, v8, v10
    v_add_f32 v100, v100, v12
    v_add_f32 v100, v100, v14
    v_add_f32 v100, v100, v16
    v_add_f32 v100, v100, v18
    v_add_f32 v100, v100, v20
    v_add_f32 v100, v100, v22
    v_add_f32 v101, v9, v11
    v_add_f32 v101, v101, v13
    v_add_f32 v101, v101, v15
    v_add_f32 v101, v101, v17
    v_add_f32 v101, v101, v19
    v_add_f32 v101, v101, v21
    v_add_f32 v101, v101, v23
    s_nop 1
    v_add_f32_dpp v100, v100, v100 quad_perm:[1,0,3,2] row_mask:0xf bank_mask:0xf
    s_nop 1
    v_add_f32_dpp v100, v100, v100 quad_perm:[2,3,0,1] row_mask:0xf bank_mask:0xf
    s_nop 1
    v_add_f32_dpp v100, v100, v100 row_half_mirror row_mask:0xf bank_mask:0xf
    s_nop 1
    v_add_f32_dpp v100, v100, v100 row_mirror row_mask:0xf bank_mask:0xf
    v_mov_b32 v104, v100
    s_nop 1
    v_permlane16_swap_b32 v100, v104
    v_add_f32 v100, v100, v104
    v_mov_b32 v104, v100
    s_nop 1
    v_permlane32_swap_b32 v100, v104
    v_add_f32 v100, v100, v104
    s_nop 1
    v_add_f32_dpp v101, v101, v101 quad_perm:[1,0,3,2] row_mask:0xf bank_mask:0xf
    s_nop 1
    v_add_f32_dpp v101, v101, v101 quad_perm:[2,3,0,1] row_mask:0xf bank_mask:0xf
    s_nop 1
    v_add_f32_dpp v101, v101, v101 row_half_mirror row_mask:0xf bank_mask:0xf
    s_nop 1
    v_add_f32_dpp v101, v101, v101 row_mirror row_mask:0xf bank_mask:0xf
    v_mov_b32 v105, v101
    s_nop 1
    v_permlane16_swap_b32 v101, v105
    v_add_f32 v101, v101, v105
    v_mov_b32 v105, v101
    s_nop 1
    v_permlane32_swap_b32 v101, v105
    v_add_f32 v101, v101, v105
    v_mul_f32 v100, 0x3b000000, v100
    v_mul_f32 v101, 0x3b000000, v101
    v_sub_f32 v44, v8, v100
    v_sub_f32 v45, v10, v100
    v_sub_f32 v46, v12, v100
    v_sub_f32 v47, v14, v100
    v_sub_f32 v48, v16, v100
    v_sub_f32 v49, v18, v100
    v_sub_f32 v50, v20, v100
    v_sub_f32 v51, v22, v100
    v_mul_f32 v102, v44, v44
    v_fma_f32 v102, v45, v45, v102
    v_fma_f32 v102, v46, v46, v102
    v_fma_f32 v102, v47, v47, v102
    v_fma_f32 v102, v48, v48, v102
    v_fma_f32 v102, v49, v49, v102
    v_fma_f32 v102, v50, v50, v102
    v_fma_f32 v102, v51, v51, v102
    v_sub_f32 v44, v9, v101
    v_sub_f32 v45, v11, v101
    v_sub_f32 v46, v13, v101
    v_sub_f32 v47, v15, v101
    v_sub_f32 v48, v17, v101
    v_sub_f32 v49, v19, v101
    v_sub_f32 v50, v21, v101
    v_sub_f32 v51, v23, v101
    v_mul_f32 v103, v44, v44
    v_fma_f32 v103, v45, v45, v103
    v_fma_f32 v103, v46, v46, v103
    v_fma_f32 v103, v47, v47, v103
    v_fma_f32 v103, v48, v48, v103
    v_fma_f32 v103, v49, v49, v103
    v_fma_f32 v103, v50, v50, v103
    v_fma_f32 v103, v51, v51, v103
    s_nop 1
    v_add_f32_dpp v102, v102, v102 quad_perm:[1,0,3,2] row_mask:0xf bank_mask:0xf
    s_nop 1
    v_add_f32_dpp v102, v102, v102 quad_perm:[2,3,0,1] row_mask:0xf bank_mask:0xf
    s_nop 1
    v_add_f32_dpp v102, v102, v102 row_half_mirror row_mask:0xf bank_mask:0xf
    s_nop 1
    v_add_f32_dpp v102, v102, v102 row_mirror row_mask:0xf bank_mask:0xf
    v_mov_b32 v104, v102
    s_nop 1
    v_permlane16_swap_b32 v102, v104
    v_add_f32 v102, v102, v104
    v_mov_b32 v104, v102
    s_nop 1
    v_permlane32_swap_b32 v102, v104
    v_add_f32 v102, v102, v104
    s_nop 1
    v_add_f32_dpp v103, v103, v103 quad_perm:[1,0,3,2] row_mask:0xf bank_mask:0xf
    s_nop 1
    v_add_f32_dpp v103, v103, v103 quad_perm:[2,3,0,1] row_mask:0xf bank_mask:0xf
    s_nop 1
    v_add_f32_dpp v103, v103, v103 row_half_mirror row_mask:0xf bank_mask:0xf
    s_nop 1
    v_add_f32_dpp v103, v103, v103 row_mirror row_mask:0xf bank_mask:0xf
    v_mov_b32 v105, v103
    s_nop 1
    v_permlane16_swap_b32 v103, v105
    v_add_f32 v103, v103, v105
    v_mov_b32 v105, v103
    s_nop 1
    v_permlane32_swap_b32 v103, v105
    v_add_f32 v103, v103, v105
    v_mul_f32 v102, 0x3b000000, v102
    v_mul_f32 v103, 0x3b000000, v103
    v_cvt_pk_bf16_f32 v104, v102, v103
    v_lshlrev_b32 v102, 16, v104
    v_and_b32 v103, 0xffff0000, v104
    v_cvt_pk_bf16_f32 v104, v100, v101
    v_lshlrev_b32 v100, 16, v104
    v_and_b32 v101, 0xffff0000, v104
    v_add_f32 v102, 0x3727c5ac, v102
    v_add_f32 v103, 0x3727c5ac, v103
    v_cvt_pk_bf16_f32 v104, v102, v103
    v_lshlrev_b32 v102, 16, v104
    v_and_b32 v103, 0xffff0000, v104
    v_sqrt_f32 v102, v102
    v_sqrt_f32 v103, v103
    s_nop 0
    v_cvt_pk_bf16_f32 v104, v102, v103
    v_lshlrev_b32 v102, 16, v104
    v_and_b32 v103, 0xffff0000, v104
    v_rcp_f32 v106, v102
    v_rcp_f32 v107, v103
    v_sub_f32 v8, v8, v100
    v_sub_f32 v9, v9, v101
    v_sub_f32 v10, v10, v100
    v_sub_f32 v11, v11, v101
    v_sub_f32 v12, v12, v100
    v_sub_f32 v13, v13, v101
    v_sub_f32 v14, v14, v100
    v_sub_f32 v15, v15, v101
    v_sub_f32 v16, v16, v100
    v_sub_f32 v17, v17, v101
    v_sub_f32 v18, v18, v100
    v_sub_f32 v19, v19, v101
    v_sub_f32 v20, v20, v100
    v_sub_f32 v21, v21, v101
    v_sub_f32 v22, v22, v100
    v_sub_f32 v23, v23, v101
    v_cvt_pk_bf16_f32 v104, v8, v9
    v_lshlrev_b32 v8, 16, v104
    v_and_b32 v9, 0xffff0000, v104
    v_cvt_pk_bf16_f32 v104, v10, v11
    v_lshlrev_b32 v10, 16, v104
    v_and_b32 v11, 0xffff0000, v104
    v_cvt_pk_bf16_f32 v104, v12, v13
    v_lshlrev_b32 v12, 16, v104
    v_and_b32 v13, 0xffff0000, v104
    v_cvt_pk_bf16_f32 v104, v14, v15
    v_lshlrev_b32 v14, 16, v104
    v_and_b32 v15, 0xffff0000, v104
    v_cvt_pk_bf16_f32 v104, v16, v17
    v_lshlrev_b32 v16, 16, v104
    v_and_b32 v17, 0xffff0000, v104
    v_cvt_pk_bf16_f32 v104, v18, v19
    v_lshlrev_b32 v18, 16, v104
    v_and_b32 v19, 0xffff0000, v104
    v_cvt_pk_bf16_f32 v104, v20, v21
    v_lshlrev_b32 v20, 16, v104
    v_and_b32 v21, 0xffff0000, v104
    v_cvt_pk_bf16_f32 v104, v22, v23
    v_lshlrev_b32 v22, 16, v104
    v_and_b32 v23, 0xffff0000, v104
    v_mul_f32 v44, v8, v106
    v_fma_f32 v45, -v44, v102, v8
    v_fma_f32 v8, v45, v106, v44
    v_mul_f32 v44, v9, v107
    v_fma_f32 v45, -v44, v103, v9
    v_fma_f32 v9, v45, v107, v44
    v_mul_f32 v44, v10, v106
    v_fma_f32 v45, -v44, v102, v10
    v_fma_f32 v10, v45, v106, v44
    v_mul_f32 v44, v11, v107
    v_fma_f32 v45, -v44, v103, v11
    v_fma_f32 v11, v45, v107, v44
    v_mul_f32 v44, v12, v106
    v_fma_f32 v45, -v44, v102, v12
    v_fma_f32 v12, v45, v106, v44
    v_mul_f32 v44, v13, v107
    v_fma_f32 v45, -v44, v103, v13
    v_fma_f32 v13, v45, v107, v44
    v_mul_f32 v44, v14, v106
    v_fma_f32 v45, -v44, v102, v14
    v_fma_f32 v14, v45, v106, v44
    v_mul_f32 v44, v15, v107
    v_fma_f32 v45, -v44, v103, v15
    v_fma_f32 v15, v45, v107, v44
    v_mul_f32 v44, v16, v106
    v_fma_f32 v45, -v44, v102, v16
    v_fma_f32 v16, v45, v106, v44
    v_mul_f32 v44, v17, v107
    v_fma_f32 v45, -v44, v103, v17
    v_fma_f32 v17, v45, v107, v44
    v_mul_f32 v44, v18, v106
    v_fma_f32 v45, -v44, v102, v18
    v_fma_f32 v18, v45, v106, v44
    v_mul_f32 v44, v19, v107
    v_fma_f32 v45, -v44, v103, v19
    v_fma_f32 v19, v45, v107, v44
    v_mul_f32 v44, v20, v106
    v_fma_f32 v45, -v44, v102, v20
    v_fma_f32 v20, v45, v106, v44
    v_mul_f32 v44, v21, v107
    v_fma_f32 v45, -v44, v103, v21
    v_fma_f32 v21, v45, v107, v44
    v_mul_f32 v44, v22, v106
    v_fma_f32 v45, -v44, v102, v22
    v_fma_f32 v22, v45, v106, v44
    v_mul_f32 v44, v23, v107
    v_fma_f32 v45, -v44, v103, v23
    v_fma_f32 v23, v45, v107, v44
    v_cvt_pk_bf16_f32 v104, v8, v9
    v_lshlrev_b32 v8, 16, v104
    v_and_b32 v9, 0xffff0000, v104
    v_cvt_pk_bf16_f32 v104, v10, v11
    v_lshlrev_b32 v10, 16, v104
    v_and_b32 v11, 0xffff0000, v104
    v_cvt_pk_bf16_f32 v104, v12, v13
    v_lshlrev_b32 v12, 16, v104
    v_and_b32 v13, 0xffff0000, v104
    v_cvt_pk_bf16_f32 v104, v14, v15
    v_lshlrev_b32 v14, 16, v104
    v_and_b32 v15, 0xffff0000, v104
    v_cvt_pk_bf16_f32 v104, v16, v17
    v_lshlrev_b32 v16, 16, v104
    v_and_b32 v17, 0xffff0000, v104
    v_cvt_pk_bf16_f32 v104, v18, v19
    v_lshlrev_b32 v18, 16, v104
    v_and_b32 v19, 0xffff0000, v104
    v_cvt_pk_bf16_f32 v104, v20, v21
    v_lshlrev_b32 v20, 16, v104
    v_and_b32 v21, 0xffff0000, v104
    v_cvt_pk_bf16_f32 v104, v22, v23
    v_lshlrev_b32 v22, 16, v104
    v_and_b32 v23, 0xffff0000, v104
    buffer_store_short_d16_hi v8, v4, s[32:35], 0 offen offset:0
    buffer_store_short_d16_hi v9, v4, s[32:35], 0 offen offset:1024
    buffer_store_short_d16_hi v10, v4, s[32:35], 0 offen offset:128
    buffer_store_short_d16_hi v11, v4, s[32:35], 0 offen offset:1152
    buffer_store_short_d16_hi v12, v4, s[32:35], 0 offen offset:256
    buffer_store_short_d16_hi v13, v4, s[32:35], 0 offen offset:1280
    buffer_store_short_d16_hi v14, v4, s[32:35], 0 offen offset:384
    buffer_store_short_d16_hi v15, v4, s[32:35], 0 offen offset:1408
    buffer_store_short_d16_hi v16, v4, s[32:35], 0 offen offset:512
    buffer_store_short_d16_hi v17, v4, s[32:35], 0 offen offset:1536
    buffer_store_short_d16_hi v18, v4, s[32:35], 0 offen offset:640
    buffer_store_short_d16_hi v19, v4, s[32:35], 0 offen offset:1664
    buffer_store_short_d16_hi v20, v4, s[32:35], 0 offen offset:768
    buffer_store_short_d16_hi v21, v4, s[32:35], 0 offen offset:1792
    buffer_store_short_d16_hi v22, v4, s[32:35], 0 offen offset:896
    buffer_store_short_d16_hi v23, v4, s[32:35], 0 offen offset:1920
    v_add_f32 v44, v8, v16
    v_add_f32 v45, v9, v17
    v_sub_f32 v52, v8, v16
    v_sub_f32 v53, v9, v17
    v_add_f32 v46, v10, v18
    v_add_f32 v47, v11, v19
    v_sub_f32 v54, v10, v18
    v_sub_f32 v55, v11, v19
    v_add_f32 v48, v12, v20
    v_add_f32 v49, v13, v21
    v_sub_f32 v56, v12, v20
    v_sub_f32 v57, v13, v21
    v_add_f32 v50, v14, v22
    v_add_f32 v51, v15, v23
    v_sub_f32 v58, v14, v22
    v_sub_f32 v59, v15, v23
    v_add_f32 v60, v54, v55
    v_sub_f32 v61, v55, v54
    v_mul_f32 v54, s36, v60
    v_mul_f32 v55, s36, v61
    v_sub_f32 v60, v59, v58
    v_add_f32 v61, v58, v59
    v_mul_f32 v58, s36, v60
    v_mul_f32 v59, s36, v61
    v_sub_f32 v59, 0, v59
    v_sub_f32 v60, 0, v56
    v_mov_b32 v56, v57
    v_mov_b32 v57, v60
    v_add_f32 v60, v44, v48
    v_add_f32 v61, v45, v49
    v_sub_f32 v62, v44, v48
    v_sub_f32 v63, v45, v49
    v_add_f32 v64, v46, v50
    v_add_f32 v65, v47, v51
    v_sub_f32 v66, v46, v50
    v_sub_f32 v67, v47, v51
    v_add_f32 v8, v60, v64
    v_add_f32 v9, v61, v65
    v_sub_f32 v16, v60, v64
    v_sub_f32 v17, v61, v65
    v_add_f32 v12, v62, v67
    v_sub_f32 v13, v63, v66
    v_sub_f32 v20, v62, v67
    v_add_f32 v21, v63, v66
    v_add_f32 v60, v52, v56
    v_add_f32 v61, v53, v57
    v_sub_f32 v62, v52, v56
    v_sub_f32 v63, v53, v57
    v_add_f32 v64, v54, v58
    v_add_f32 v65, v55, v59
    v_sub_f32 v66, v54, v58
    v_sub_f32 v67, v55, v59
    v_add_f32 v10, v60, v64
    v_add_f32 v11, v61, v65
    v_sub_f32 v18, v60, v64
    v_sub_f32 v19, v61, v65
    v_add_f32 v14, v62, v67
    v_sub_f32 v15, v63, v66
    v_sub_f32 v22, v62, v67
    v_add_f32 v23, v63, v66
    v_mul_f32 v104, v11, v71
    v_mul_f32 v105, v10, v71
    v_fma_f32 v10, v10, v70, -v104
    v_fma_f32 v11, v11, v70, v105
    v_mul_f32 v104, v13, v73
    v_mul_f32 v105, v12, v73
    v_fma_f32 v12, v12, v72, -v104
    v_fma_f32 v13, v13, v72, v105
    v_mul_f32 v104, v15, v75
    v_mul_f32 v105, v14, v75
    v_fma_f32 v14, v14, v74, -v104
    v_fma_f32 v15, v15, v74, v105
    v_mul_f32 v104, v17, v77
    v_mul_f32 v105, v16, v77
    v_fma_f32 v16, v16, v76, -v104
    v_fma_f32 v17, v17, v76, v105
    v_mul_f32 v104, v19, v79
    v_mul_f32 v105, v18, v79
    v_fma_f32 v18, v18, v78, -v104
    v_fma_f32 v19, v19, v78, v105
    v_mul_f32 v104, v21, v81
    v_mul_f32 v105, v20, v81
    v_fma_f32 v20, v20, v80, -v104
    v_fma_f32 v21, v21, v80, v105
    v_mul_f32 v104, v23, v83
    v_mul_f32 v105, v22, v83
    v_fma_f32 v22, v22, v82, -v104
    v_fma_f32 v23, v23, v82, v105
    ds_write_b64 v120, v[8:9] offset:0
    ds_write_b64 v120, v[10:11] offset:576
    ds_write_b64 v120, v[12:13] offset:1152
    ds_write_b64 v120, v[14:15] offset:1728
    ds_write_b64 v120, v[16:17] offset:2304
    ds_write_b64 v120, v[18:19] offset:2880
    ds_write_b64 v120, v[20:21] offset:3456
    ds_write_b64 v120, v[22:23] offset:4032
    s_waitcnt lgkmcnt(0)
    ds_read_b64 v[8:9], v121 offset:0
    ds_read_b64 v[10:11], v121 offset:64
    ds_read_b64 v[12:13], v121 offset:128
    ds_read_b64 v[14:15], v121 offset:192
    ds_read_b64 v[16:17], v121 offset:256
    ds_read_b64 v[18:19], v121 offset:320
    ds_read_b64 v[20:21], v121 offset:384
    ds_read_b64 v[22:23], v121 offset:448
    s_waitcnt lgkmcnt(0)
    v_add_f32 v44, v8, v16
    v_add_f32 v45, v9, v17
    v_sub_f32 v52, v8, v16
    v_sub_f32 v53, v9, v17
    v_add_f32 v46, v10, v18
    v_add_f32 v47, v11, v19
    v_sub_f32 v54, v10, v18
    v_sub_f32 v55, v11, v19
    v_add_f32 v48, v12, v20
    v_add_f32 v49, v13, v21
    v_sub_f32 v56, v12, v20
    v_sub_f32 v57, v13, v21
    v_add_f32 v50, v14, v22
    v_add_f32 v51, v15, v23
    v_sub_f32 v58, v14, v22
    v_sub_f32 v59, v15, v23
    v_add_f32 v60, v54, v55
    v_sub_f32 v61, v55, v54
    v_mul_f32 v54, s36, v60
    v_mul_f32 v55, s36, v61
    v_sub_f32 v60, v59, v58
    v_add_f32 v61, v58, v59
    v_mul_f32 v58, s36, v60
    v_mul_f32 v59, s36, v61
    v_sub_f32 v59, 0, v59
    v_sub_f32 v60, 0, v56
    v_mov_b32 v56, v57
    v_mov_b32 v57, v60
    v_add_f32 v60, v44, v48
    v_add_f32 v61, v45, v49
    v_sub_f32 v62, v44, v48
    v_sub_f32 v63, v45, v49
    v_add_f32 v64, v46, v50
    v_add_f32 v65, v47, v51
    v_sub_f32 v66, v46, v50
    v_sub_f32 v67, v47, v51
    v_add_f32 v8, v60, v64
    v_add_f32 v9, v61, v65
    v_sub_f32 v16, v60, v64
    v_sub_f32 v17, v61, v65
    v_add_f32 v12, v62, v67
    v_sub_f32 v13, v63, v66
    v_sub_f32 v20, v62, v67
    v_add_f32 v21, v63, v66
    v_add_f32 v60, v52, v56
    v_add_f32 v61, v53, v57
    v_sub_f32 v62, v52, v56
    v_sub_f32 v63, v53, v57
    v_add_f32 v64, v54, v58
    v_add_f32 v65, v55, v59
    v_sub_f32 v66, v54, v58
    v_sub_f32 v67, v55, v59
    v_add_f32 v10, v60, v64
    v_add_f32 v11, v61, v65
    v_sub_f32 v18, v60, v64
    v_sub_f32 v19, v61, v65
    v_add_f32 v14, v62, v67
    v_sub_f32 v15, v63, v66
    v_sub_f32 v22, v62, v67
    v_add_f32 v23, v63, v66
    v_mul_f32 v104, v9, v85
    v_mul_f32 v105, v8, v85
    v_fma_f32 v8, v8, v84, -v104
    v_fma_f32 v9, v9, v84, v105
    v_mul_f32 v104, v11, v87
    v_mul_f32 v105, v10, v87
    v_fma_f32 v10, v10, v86, -v104
    v_fma_f32 v11, v11, v86, v105
    v_mul_f32 v104, v13, v89
    v_mul_f32 v105, v12, v89
    v_fma_f32 v12, v12, v88, -v104
    v_fma_f32 v13, v13, v88, v105
    v_mul_f32 v104, v15, v91
    v_mul_f32 v105, v14, v91
    v_fma_f32 v14, v14, v90, -v104
    v_fma_f32 v15, v15, v90, v105
    v_mul_f32 v104, v17, v93
    v_mul_f32 v105, v16, v93
    v_fma_f32 v16, v16, v92, -v104
    v_fma_f32 v17, v17, v92, v105
    v_mul_f32 v104, v19, v95
    v_mul_f32 v105, v18, v95
    v_fma_f32 v18, v18, v94, -v104
    v_fma_f32 v19, v19, v94, v105
    v_mul_f32 v104, v21, v97
    v_mul_f32 v105, v20, v97
    v_fma_f32 v20, v20, v96, -v104
    v_fma_f32 v21, v21, v96, v105
    v_mul_f32 v104, v23, v99
    v_mul_f32 v105, v22, v99
    v_fma_f32 v22, v22, v98, -v104
    v_fma_f32 v23, v23, v98, v105
    ds_write_b64 v122, v[8:9] offset:0
    ds_write_b64 v122, v[10:11] offset:576
    ds_write_b64 v122, v[12:13] offset:1152
    ds_write_b64 v122, v[14:15] offset:1728
    ds_write_b64 v122, v[16:17] offset:2304
    ds_write_b64 v122, v[18:19] offset:2880
    ds_write_b64 v122, v[20:21] offset:3456
    ds_write_b64 v122, v[22:23] offset:4032
    s_waitcnt lgkmcnt(0)
    ds_read_b64 v[8:9], v123 offset:0
    ds_read_b64 v[10:11], v123 offset:8
    ds_read_b64 v[12:13], v123 offset:16
    ds_read_b64 v[14:15], v123 offset:24
    ds_read_b64 v[16:17], v123 offset:32
    ds_read_b64 v[18:19], v123 offset:40
    ds_read_b64 v[20:21], v123 offset:48
    ds_read_b64 v[22:23], v123 offset:56
    s_waitcnt lgkmcnt(0)
    v_add_f32 v44, v8, v16
    v_add_f32 v45, v9, v17
    v_sub_f32 v52, v8, v16
    v_sub_f32 v53, v9, v17
    v_add_f32 v46, v10, v18
    v_add_f32 v47, v11, v19
    v_sub_f32 v54, v10, v18
    v_sub_f32 v55, v11, v19
    v_add_f32 v48, v12, v20
    v_add_f32 v49, v13, v21
    v_sub_f32 v56, v12, v20
    v_sub_f32 v57, v13, v21
    v_add_f32 v50, v14, v22
    v_add_f32 v51, v15, v23
    v_sub_f32 v58, v14, v22
    v_sub_f32 v59, v15, v23
    v_add_f32 v60, v54, v55
    v_sub_f32 v61, v55, v54
    v_mul_f32 v54, s36, v60
    v_mul_f32 v55, s36, v61
    v_sub_f32 v60, v59, v58
    v_add_f32 v61, v58, v59
    v_mul_f32 v58, s36, v60
    v_mul_f32 v59, s36, v61
    v_sub_f32 v59, 0, v59
    v_sub_f32 v60, 0, v56
    v_mov_b32 v56, v57
    v_mov_b32 v57, v60
    v_add_f32 v60, v44, v48
    v_add_f32 v61, v45, v49
    v_sub_f32 v62, v44, v48
    v_sub_f32 v63, v45, v49
    v_add_f32 v64, v46, v50
    v_add_f32 v65, v47, v51
    v_sub_f32 v66, v46, v50
    v_sub_f32 v67, v47, v51
    v_add_f32 v8, v60, v64
    v_add_f32 v9, v61, v65
    v_sub_f32 v16, v60, v64
    v_sub_f32 v17, v61, v65
    v_add_f32 v12, v62, v67
    v_sub_f32 v13, v63, v66
    v_sub_f32 v20, v62, v67
    v_add_f32 v21, v63, v66
    v_add_f32 v60, v52, v56
    v_add_f32 v61, v53, v57
    v_sub_f32 v62, v52, v56
    v_sub_f32 v63, v53, v57
    v_add_f32 v64, v54, v58
    v_add_f32 v65, v55, v59
    v_sub_f32 v66, v54, v58
    v_sub_f32 v67, v55, v59
    v_add_f32 v10, v60, v64
    v_add_f32 v11, v61, v65
    v_sub_f32 v18, v60, v64
    v_sub_f32 v19, v61, v65
    v_add_f32 v14, v62, v67
    v_sub_f32 v15, v63, v66
    v_sub_f32 v22, v62, v67
    v_add_f32 v23, v63, v66
    ds_write_b64 v120, v[16:17] offset:0
    ds_write_b64 v120, v[18:19] offset:512
    ds_write_b64 v120, v[20:21] offset:1024
    ds_write_b64 v120, v[22:23] offset:1536
    ds_write_b64 v120, v[8:9] offset:2048
    s_waitcnt lgkmcnt(0)
    ds_read_b64 v[44:45], v124 offset:1536
    ds_read_b64 v[46:47], v124 offset:1024
    ds_read_b64 v[48:49], v124 offset:512
    ds_read_b64 v[50:51], v124 offset:0
    v_lshlrev_b32 v128, 13, v1
    v_lshl_add_u32 v128, v3, 2, v128
    v_lshlrev_b32 v129, 14, v1
    v_lshl_add_u32 v129, v3, 3, v129
    s_waitcnt lgkmcnt(0)
    v_add_f32 v68, v8, v44
    v_sub_f32 v69, v9, v45
    v_add_f32 v70, v9, v45
    v_sub_f32 v71, v44, v8
    s_mov_b32 s41, 0x0
    buffer_store_dwordx4 v[68:71], v129, s[24:27], s41 offen
    s_mov_b32 s42, 0x0
    v_add_f32 v72, v10, v46
    v_sub_f32 v73, v11, v47
    v_add_f32 v74, v11, v47
    v_sub_f32 v75, v46, v10
    s_mov_b32 s41, 0x100000
    buffer_store_dwordx4 v[72:75], v129, s[24:27], s41 offen
    s_mov_b32 s42, 0x80000
    v_add_f32 v76, v12, v48
    v_sub_f32 v77, v13, v49
    v_add_f32 v78, v13, v49
    v_sub_f32 v79, v48, v12
    s_mov_b32 s41, 0x200000
    buffer_store_dwordx4 v[76:79], v129, s[24:27], s41 offen
    s_mov_b32 s42, 0x100000
    v_add_f32 v80, v14, v50
    v_sub_f32 v81, v15, v51
    v_add_f32 v82, v15, v51
    v_sub_f32 v83, v50, v14
    s_mov_b32 s41, 0x300000
    buffer_store_dwordx4 v[80:83], v129, s[24:27], s41 offen
    s_mov_b32 s42, 0x180000
    v_add_f32 v84, v16, v16
    v_sub_f32 v85, v17, v17
    v_add_f32 v86, v17, v17
    v_sub_f32 v87, v16, v16
    v_cmp_eq_u32 vcc, 0, v1
    s_and_saveexec_b64 s[44:45], vcc
    s_mov_b32 s41, 0x400000
    buffer_store_dwordx4 v[84:87], v129, s[24:27], s41 offen
    s_mov_b32 s42, 0x200000
L_rows_done:
    s_endpgm
L_rows_wdt:
    s_sub_u32 s2, s2, 256
    s_load_dwordx2 s[10:11], s[0:1], 72
    s_load_dwordx2 s[4:5], s[0:1], 48
    s_lshr_b32 s46, s2, 3
    s_and_b32 s47, s2, 7
    s_lshl_b32 s48, s46, 16
    s_lshl_b32 s49, s47, 7
    s_add_u32 s48, s48, s49
    s_add_u32 s50, s48, 0x4000
    s_mul_i32 s51, s47, 0x38000
    s_lshl_b32 s49, s46, 11
    s_add_u32 s51, s51, s49
    s_mov_b32 s52, 0x05040100
    s_mov_b32 s53, 0x07060302
    v_and_b32 v1, 7, v0
    v_bfe_u32 v2, v0, 3, 2
    v_bfe_u32 v5, v0, 5, 2
    v_lshrrev_b32 v6, 7, v0
    v_lshlrev_b32 v3, 15, v6
    v_lshl_add_u32 v3, v2, 12, v3
    v_lshl_add_u32 v3, v5, 5, v3
    v_lshl_add_u32 v3, v1, 2, v3
    v_mul_u32_u24 v4, 0xe000, v5
    v_lshl_add_u32 v4, v6, 10, v4
    v_lshl_add_u32 v4, v2, 8, v4
    v_lshl_add_u32 v4, v1, 5, v4
    s_waitcnt lgkmcnt(0)
    s_mov_b32 s12, s4
    s_mov_b32 s13, s5
    s_mov_b32 s14, 0x1c0000
    s_mov_b32 s15, 0x00020000
    s_add_u32 s16, s10, 0x1400000
    s_addc_u32 s17, s11, 0
    s_mov_b32 s18, 0x1c0000
    s_mov_b32 s19, 0x00020000
    buffer_load_dword v10, v3, s[12:15], s48 offen offset:0
    buffer_load_dword v11, v3, s[12:15], s48 offen offset:1024
    buffer_load_dword v12, v3, s[12:15], s48 offen offset:2048
    buffer_load_dword v13, v3, s[12:15], s48 offen offset:3072
    buffer_load_dword v14, v3, s[12:15], s50 offen offset:0
    buffer_load_dword v15, v3, s[12:15], s50 offen offset:1024
    buffer_load_dword v16, v3, s[12:15], s50 offen offset:2048
    buffer_load_dword v17, v3, s[12:15], s50 offen offset:3072
    s_waitcnt vmcnt(0)
    v_perm_b32 v20, v11, v10, s52
    v_perm_b32 v21, v13, v12, s52
    v_perm_b32 v22, v15, v14, s52
    v_perm_b32 v23, v17, v16, s52
    v_perm_b32 v24, v11, v10, s53
    v_perm_b32 v25, v13, v12, s53
    v_perm_b32 v26, v15, v14, s53
    v_perm_b32 v27, v17, v16, s53
    buffer_store_dwordx4 v[20:23], v4, s[16:19], s51 offen
    buffer_store_dwordx4 v[24:27], v4, s[16:19], s51 offen offset:16
    s_endpgm

.globl gemm1_kernel
.p2align 8
.type gemm1_kernel,@function
gemm1_kernel:
    s_cmp_ge_u32 s2, 256
    s_cbranch_scc1 L_g1_done
    s_cmp_ge_u32 s2, 224
    s_cbranch_scc1 L_g1_wdt
    s_load_dwordx2 s[10:11], s[0:1], 72
    s_load_dwordx2 s[4:5], s[0:1], 32
    s_load_dwordx2 s[6:7], s[0:1], 40
    s_and_b32 s46, s2, 3
    s_lshl_b32 s46, s46, 2
    s_bfe_u32 s47, s2, 0x20003
    s_add_u32 s46, s46, s47
    s_bfe_u32 s47, s2, 0x10002
    s_mul_i32 s47, s47, 7
    s_lshr_b32 s48, s2, 5
    s_add_u32 s47, s47, s48
    s_lshl_b32 s48, s46, 17
    s_lshl_b32 s49, s47, 8
    s_waitcnt lgkmcnt(0)
    s_add_u32 s12, s10, 0x800000
    s_addc_u32 s13, s11, 0
    s_mov_b32 s14, 0x200000
    s_mov_b32 s15, 0x00020000
    s_mov_b32 s16, s4
    s_mov_b32 s17, s5
    s_mov_b32 s18, 0x1c0000
    s_mov_b32 s19, 0x00020000
    s_mov_b32 s20, s6
    s_mov_b32 s21, s7
    s_mov_b32 s22, 0x1c0000
    s_mov_b32 s23, 0x00020000
    s_add_u32 s24, s10, 0xa00000
    s_addc_u32 s25, s11, 0
    s_mov_b32 s26, 0x700000
    s_mov_b32 s27, 0x00020000
    v_and_b32 v1, 63, v0
    v_lshrrev_b32 v2, 6, v0
    s_nop 0
    v_readfirstlane_b32 s50, v2
    s_nop 3
    s_lshl_b32 s51, s50, 10
    v_lshrrev_b32 v40, 3, v1
    v_and_b32 v41, 7, v1
    v_xor_b32 v42, v41, v40
    v_lshl_add_u32 v43, v2, 3, v40
    v_mul_u32_u24 v3, 0x400, v43
    v_lshl_add_u32 v3, v42, 4, v3
    v_and_b32 v42, 2, v40
    v_and_b32 v44, 1, v2
    v_lshl_or_b32 v42, v44, 2, v42
    v_xor_b32 v42, v41, v42
    v_mul_u32_u24 v4, 0xe00, v43
    v_lshl_add_u32 v4, v42, 4, v4
    s_add_u32 m0, s51, 0x0
    s_add_u32 s52, s48, 0x0
    buffer_load_dwordx4 v3, s[12:15], s52 offen lds
    s_add_u32 m0, s51, 0x1000
    s_add_u32 s52, s48, 0x8000
    buffer_load_dwordx4 v3, s[12:15], s52 offen lds
    s_add_u32 m0, s51, 0x2000
    s_add_u32 s52, s48, 0x10000
    buffer_load_dwordx4 v3, s[12:15], s52 offen lds
    s_add_u32 m0, s51, 0x3000
    s_add_u32 s52, s48, 0x18000
    buffer_load_dwordx4 v3, s[12:15], s52 offen lds
    s_add_u32 m0, s51, 0x4000
    s_add_u32 s52, s49, 0x0
    buffer_load_dwordx4 v4, s[16:19], s52 offen lds
    s_add_u32 m0, s51, 0x5000
    s_add_u32 s52, s49, 0x1c000
    buffer_load_dwordx4 v4, s[16:19], s52 offen lds
    s_add_u32 m0, s51, 0x6000
    s_add_u32 s52, s49, 0x80
    buffer_load_dwordx4 v4, s[16:19], s52 offen lds
    s_add_u32 m0, s51, 0x7000
    s_add_u32 s52, s49, 0x1c080
    buffer_load_dwordx4 v4, s[16:19], s52 offen lds
    s_add_u32 m0, s51, 0x8000
    s_add_u32 s52, s49, 0x0
    buffer_load_dwordx4 v4, s[20:23], s52 offen lds
    s_add_u32 m0, s51, 0x9000
    s_add_u32 s52, s49, 0x1c000
    buffer_load_dwordx4 v4, s[20:23], s52 offen lds
    s_add_u32 m0, s51, 0xa000
    s_add_u32 s52, s49, 0x80
    buffer_load_dwordx4 v4, s[20:23], s52 offen lds
    s_add_u32 m0, s51, 0xb000
    s_add_u32 s52, s49, 0x1c080
    buffer_load_dwordx4 v4, s[20:23], s52 offen lds
    s_add_u32 m0, s51, 0xc000
    s_add_u32 s52, s48, 0x80
    buffer_load_dwordx4 v3, s[12:15], s52 offen lds
    s_add_u32 m0, s51, 0xd000
    s_add_u32 s52, s48, 0x8080
    buffer_load_dwordx4 v3, s[12:15], s52 offen lds
    s_add_u32 m0, s51, 0xe000
    s_add_u32 s52, s48, 0x10080
    buffer_load_dwordx4 v3, s[12:15], s52 offen lds
    s_add_u32 m0, s51, 0xf000
    s_add_u32 s52, s48, 0x18080
    buffer_load_dwordx4 v3, s[12:15], s52 offen lds
    s_add_u32 m0, s51, 0x10000
    s_add_u32 s52, s49, 0x38000
    buffer_load_dwordx4 v4, s[16:19], s52 offen lds
    s_add_u32 m0, s51, 0x11000
    s_add_u32 s52, s49, 0x54000
    buffer_load_dwordx4 v4, s[16:19], s52 offen lds
    s_add_u32 m0, s51, 0x12000
    s_add_u32 s52, s49, 0x38080
    buffer_load_dwordx4 v4, s[16:19], s52 offen lds
    s_add_u32 m0, s51, 0x13000
    s_add_u32 s52, s49, 0x54080
    buffer_load_dwordx4 v4, s[16:19], s52 offen lds
    s_add_u32 m0, s51, 0x14000
    s_add_u32 s52, s49, 0x38000
    buffer_load_dwordx4 v4, s[20:23], s52 offen lds
    s_add_u32 m0, s51, 0x15000
    s_add_u32 s52, s49, 0x54000
    buffer_load_dwordx4 v4, s[20:23], s52 offen lds
    s_add_u32 m0, s51, 0x16000
    s_add_u32 s52, s49, 0x38080
    buffer_load_dwordx4 v4, s[20:23], s52 offen lds
    s_add_u32 m0, s51, 0x17000
    s_add_u32 s52, s49, 0x54080
    buffer_load_dwordx4 v4, s[20:23], s52 offen lds
    v_lshrrev_b32 v45, 1, v2
    v_and_b32 v46, 1, v2
    v_and_b32 v40, 15, v1
    v_mul_u32_u24 v41, 64, v45
    v_add_u32 v40, v40, v41
    v_lshlrev_b32 v40, 7, v40
    v_lshrrev_b32 v41, 4, v1
    v_and_b32 v42, 7, v1
    v_xor_b32 v41, v41, v42
    v_lshl_add_u32 v5, v41, 4, v40
    v_xor_b32 v6, 64, v5
    v_lshrrev_b32 v40, 4, v1
    v_bfe_u32 v41, v1, 2, 2
    v_and_b32 v42, 3, v1
    v_lshl_add_u32 v43, v40, 3, v41
    v_lshlrev_b32 v43, 7, v43
    v_and_b32 v44, 2, v41
    v_and_b32 v40, 1, v40
    v_lshl_or_b32 v44, v40, 2, v44
    v_and_b32 v40, 1, v42
    v_lshl_add_u32 v43, v40, 3, v43
    v_lshrrev_b32 v42, 1, v42
    v_add_u32 v43, 0x4000, v43
    v_lshl_add_u32 v43, v46, 13, v43
    v_mov_b32 v47, 0
    v_add_u32 v47, v47, v42
    v_xor_b32 v47, v47, v44
    v_lshl_add_u32 v8, v47, 4, v43
    v_mov_b32 v47, 2
    v_add_u32 v47, v47, v42
    v_xor_b32 v47, v47, v44
    v_lshl_add_u32 v9, v47, 4, v43
    v_mov_b32 v47, 4
    v_add_u32 v47, v47, v42
    v_xor_b32 v47, v47, v44
    v_lshl_add_u32 v10, v47, 4, v43
    v_mov_b32 v47, 6
    v_add_u32 v47, v47, v42
    v_xor_b32 v47, v47, v44
    v_lshl_add_u32 v11, v47, 4, v43
    v_add_u32 v16, 0x0, v5
    v_add_u32 v17, 0x0, v6
    v_add_u32 v18, 0x0, v8
    v_add_u32 v19, 0x0, v9
    v_add_u32 v20, 0x0, v10
    v_add_u32 v21, 0x0, v11
    v_add_u32 v22, 0xc000, v5
    v_add_u32 v23, 0xc000, v6
    v_add_u32 v24, 0xc000, v8
    v_add_u32 v25, 0xc000, v9
    v_add_u32 v26, 0xc000, v10
    v_add_u32 v27, 0xc000, v11
    v_add_u32 v28, 0x18000, v5
    v_add_u32 v29, 0x18000, v6
    v_add_u32 v30, 0x18000, v8
    v_add_u32 v31, 0x18000, v9
    v_add_u32 v32, 0x18000, v10
    v_add_u32 v33, 0x18000, v11
    s_waitcnt vmcnt(12)
    s_barrier
    s_add_u32 m0, s51, 0x18000
    s_add_u32 s52, s48, 0x100
    buffer_load_dwordx4 v3, s[12:15], s52 offen lds
    s_add_u32 m0, s51, 0x19000
    s_add_u32 s52, s48, 0x8100
    buffer_load_dwordx4 v3, s[12:15], s52 offen lds
    s_add_u32 m0, s51, 0x1a000
    s_add_u32 s52, s48, 0x10100
    buffer_load_dwordx4 v3, s[12:15], s52 offen lds
    s_add_u32 m0, s51, 0x1b000
    s_add_u32 s52, s48, 0x18100
    buffer_load_dwordx4 v3, s[12:15], s52 offen lds
    s_add_u32 m0, s51, 0x1c000
    s_add_u32 s52, s49, 0x70000
    buffer_load_dwordx4 v4, s[16:19], s52 offen lds
    s_add_u32 m0, s51, 0x1d000
    s_add_u32 s52, s49, 0x8c000
    buffer_load_dwordx4 v4, s[16:19], s52 offen lds
    s_add_u32 m0, s51, 0x1e000
    s_add_u32 s52, s49, 0x70080
    buffer_load_dwordx4 v4, s[16:19], s52 offen lds
    s_add_u32 m0, s51, 0x1f000
    s_add_u32 s52, s49, 0x8c080
    buffer_load_dwordx4 v4, s[16:19], s52 offen lds
    s_add_u32 m0, s51, 0x20000
    s_add_u32 s52, s49, 0x70000
    buffer_load_dwordx4 v4, s[20:23], s52 offen lds
    s_add_u32 m0, s51, 0x21000
    s_add_u32 s52, s49, 0x8c000
    buffer_load_dwordx4 v4, s[20:23], s52 offen lds
    s_add_u32 m0, s51, 0x22000
    s_add_u32 s52, s49, 0x70080
    buffer_load_dwordx4 v4, s[20:23], s52 offen lds
    s_add_u32 m0, s51, 0x23000
    s_add_u32 s52, s49, 0x8c080
    buffer_load_dwordx4 v4, s[20:23], s52 offen lds
    ds_read_b128 v[64:67], v16 offset:0
    ds_read_b128 v[68:71], v16 offset:2048
    ds_read_b128 v[72:75], v16 offset:4096
    ds_read_b128 v[76:79], v16 offset:6144
    ds_read_b64_tr_b16 v[96:97], v18 offset:0
    ds_read_b64_tr_b16 v[98:99], v18 offset:512
    ds_read_b64_tr_b16 v[100:101], v19 offset:0
    ds_read_b64_tr_b16 v[102:103], v19 offset:512
    ds_read_b64_tr_b16 v[104:105], v20 offset:0
    ds_read_b64_tr_b16 v[106:107], v20 offset:512
    ds_read_b64_tr_b16 v[108:109], v21 offset:0
    ds_read_b64_tr_b16 v[110:111], v21 offset:512
    s_waitcnt lgkmcnt(0)
    v_mfma_f32_16x16x32_bf16 v[128:131], v[96:99], v[64:67], 0
    ds_read_b64_tr_b16 v[112:113], v18 offset:16384
    v_mfma_f32_16x16x32_bf16 v[132:135], v[96:99], v[68:71], 0
    ds_read_b64_tr_b16 v[114:115], v18 offset:16896
    v_mfma_f32_16x16x32_bf16 v[136:139], v[96:99], v[72:75], 0
    ds_read_b64_tr_b16 v[116:117], v19 offset:16384
    v_mfma_f32_16x16x32_bf16 v[140:143], v[96:99], v[76:79], 0
    ds_read_b64_tr_b16 v[118:119], v19 offset:16896
    v_mfma_f32_16x16x32_bf16 v[144:147], v[100:103], v[64:67], 0
    ds_read_b64_tr_b16 v[120:121], v20 offset:16384
    v_mfma_f32_16x16x32_bf16 v[148:151], v[100:103], v[68:71], 0
    ds_read_b64_tr_b16 v[122:123], v20 offset:16896
    v_mfma_f32_16x16x32_bf16 v[152:155], v[100:103], v[72:75], 0
    ds_read_b64_tr_b16 v[124:125], v21 offset:16384
    v_mfma_f32_16x16x32_bf16 v[156:159], v[100:103], v[76:79], 0
    ds_read_b64_tr_b16 v[126:127], v21 offset:16896
    v_mfma_f32_16x16x32_bf16 v[160:163], v[104:107], v[64:67], 0
    v_mfma_f32_16x16x32_bf16 v[164:167], v[104:107], v[68:71], 0
    v_mfma_f32_16x16x32_bf16 v[168:171], v[104:107], v[72:75], 0
    v_mfma_f32_16x16x32_bf16 v[172:175], v[104:107], v[76:79], 0
    v_mfma_f32_16x16x32_bf16 v[176:179], v[108:111], v[64:67], 0
    v_mfma_f32_16x16x32_bf16 v[180:183], v[108:111], v[68:71], 0
    v_mfma_f32_16x16x32_bf16 v[184:187], v[108:111], v[72:75], 0
    v_mfma_f32_16x16x32_bf16 v[188:191], v[108:111], v[76:79], 0
    s_waitcnt lgkmcnt(0)
    v_mfma_f32_16x16x32_bf16 v[192:195], v[112:115], v[64:67], 0
    ds_read_b128 v[80:83], v17 offset:0
    ds_read_b128 v[84:87], v17 offset:2048
    v_mfma_f32_16x16x32_bf16 v[196:199], v[112:115], v[68:71], 0
    ds_read_b128 v[88:91], v17 offset:4096
    v_mfma_f32_16x16x32_bf16 v[200:203], v[112:115], v[72:75], 0
    ds_read_b128 v[92:95], v17 offset:6144
    ds_read_b64_tr_b16 v[96:97], v18 offset:4096
    v_mfma_f32_16x16x32_bf16 v[204:207], v[112:115], v[76:79], 0
    ds_read_b64_tr_b16 v[98:99], v18 offset:4608
    v_mfma_f32_16x16x32_bf16 v[208:211], v[116:119], v[64:67], 0
    ds_read_b64_tr_b16 v[100:101], v19 offset:4096
    ds_read_b64_tr_b16 v[102:103], v19 offset:4608
    v_mfma_f32_16x16x32_bf16 v[212:215], v[116:119], v[68:71], 0
    ds_read_b64_tr_b16 v[104:105], v20 offset:4096
    v_mfma_f32_16x16x32_bf16 v[216:219], v[116:119], v[72:75], 0
    ds_read_b64_tr_b16 v[106:107], v20 offset:4608
    ds_read_b64_tr_b16 v[108:109], v21 offset:4096
    v_mfma_f32_16x16x32_bf16 v[220:223], v[116:119], v[76:79], 0
    ds_read_b64_tr_b16 v[110:111], v21 offset:4608
    v_mfma_f32_16x16x32_bf16 v[224:227], v[120:123], v[64:67], 0
    v_mfma_f32_16x16x32_bf16 v[228:231], v[120:123], v[68:71], 0
    v_mfma_f32_16x16x32_bf16 v[232:235], v[120:123], v[72:75], 0
    v_mfma_f32_16x16x32_bf16 v[236:239], v[120:123], v[76:79], 0
    v_mfma_f32_16x16x32_bf16 v[240:243], v[124:127], v[64:67], 0
    v_mfma_f32_16x16x32_bf16 v[244:247], v[124:127], v[68:71], 0
    v_mfma_f32_16x16x32_bf16 v[248:251], v[124:127], v[72:75], 0
    v_mfma_f32_16x16x32_bf16 v[252:255], v[124:127], v[76:79], 0
    s_waitcnt lgkmcnt(0)
    v_mfma_f32_16x16x32_bf16 v[128:131], v[96:99], v[80:83], v[128:131]
    ds_read_b64_tr_b16 v[112:113], v18 offset:20480
    v_mfma_f32_16x16x32_bf16 v[132:135], v[96:99], v[84:87], v[132:135]
    ds_read_b64_tr_b16 v[114:115], v18 offset:20992
    v_mfma_f32_16x16x32_bf16 v[136:139], v[96:99], v[88:91], v[136:139]
    ds_read_b64_tr_b16 v[116:117], v19 offset:20480
    v_mfma_f32_16x16x32_bf16 v[140:143], v[96:99], v[92:95], v[140:143]
    ds_read_b64_tr_b16 v[118:119], v19 offset:20992
    v_mfma_f32_16x16x32_bf16 v[144:147], v[100:103], v[80:83], v[144:147]
    ds_read_b64_tr_b16 v[120:121], v20 offset:20480
    v_mfma_f32_16x16x32_bf16 v[148:151], v[100:103], v[84:87], v[148:151]
    ds_read_b64_tr_b16 v[122:123], v20 offset:20992
    v_mfma_f32_16x16x32_bf16 v[152:155], v[100:103], v[88:91], v[152:155]
    ds_read_b64_tr_b16 v[124:125], v21 offset:20480
    v_mfma_f32_16x16x32_bf16 v[156:159], v[100:103], v[92:95], v[156:159]
    ds_read_b64_tr_b16 v[126:127], v21 offset:20992
    v_mfma_f32_16x16x32_bf16 v[160:163], v[104:107], v[80:83], v[160:163]
    v_mfma_f32_16x16x32_bf16 v[164:167], v[104:107], v[84:87], v[164:167]
    v_mfma_f32_16x16x32_bf16 v[168:171], v[104:107], v[88:91], v[168:171]
    v_mfma_f32_16x16x32_bf16 v[172:175], v[104:107], v[92:95], v[172:175]
    v_mfma_f32_16x16x32_bf16 v[176:179], v[108:111], v[80:83], v[176:179]
    v_mfma_f32_16x16x32_bf16 v[180:183], v[108:111], v[84:87], v[180:183]
    v_mfma_f32_16x16x32_bf16 v[184:187], v[108:111], v[88:91], v[184:187]
    v_mfma_f32_16x16x32_bf16 v[188:191], v[108:111], v[92:95], v[188:191]
    s_waitcnt lgkmcnt(0)
    s_waitcnt vmcnt(12)
    s_barrier
    v_mfma_f32_16x16x32_bf16 v[192:195], v[112:115], v[80:83], v[192:195]
    ds_read_b128 v[64:67], v22 offset:0
    ds_read_b128 v[68:71], v22 offset:2048
    s_add_u32 m0, s51, 0x0
    s_add_u32 s52, s48, 0x180
    buffer_load_dwordx4 v3, s[12:15], s52 offen lds
    v_mfma_f32_16x16x32_bf16 v[196:199], v[112:115], v[84:87], v[196:199]
    ds_read_b128 v[72:75], v22 offset:4096
    v_mfma_f32_16x16x32_bf16 v[200:203], v[112:115], v[88:91], v[200:203]
    ds_read_b128 v[76:79], v22 offset:6144
    ds_read_b64_tr_b16 v[96:97], v24 offset:0
    v_mfma_f32_16x16x32_bf16 v[204:207], v[112:115], v[92:95], v[204:207]
    ds_read_b64_tr_b16 v[98:99], v24 offset:512
    v_mfma_f32_16x16x32_bf16 v[208:211], v[116:119], v[80:83], v[208:211]
    ds_read_b64_tr_b16 v[100:101], v25 offset:0
    ds_read_b64_tr_b16 v[102:103], v25 offset:512
    v_mfma_f32_16x16x32_bf16 v[212:215], v[116:119], v[84:87], v[212:215]
    ds_read_b64_tr_b16 v[104:105], v26 offset:0
    s_add_u32 m0, s51, 0x1000
    s_add_u32 s52, s48, 0x8180
    buffer_load_dwordx4 v3, s[12:15], s52 offen lds
    v_mfma_f32_16x16x32_bf16 v[216:219], v[116:119], v[88:91], v[216:219]
    ds_read_b64_tr_b16 v[106:107], v26 offset:512
    ds_read_b64_tr_b16 v[108:109], v27 offset:0
    v_mfma_f32_16x16x32_bf16 v[220:223], v[116:119], v[92:95], v[220:223]
    ds_read_b64_tr_b16 v[110:111], v27 offset:512
    v_mfma_f32_16x16x32_bf16 v[224:227], v[120:123], v[80:83], v[224:227]
    v_mfma_f32_16x16x32_bf16 v[228:231], v[120:123], v[84:87], v[228:231]
    v_mfma_f32_16x16x32_bf16 v[232:235], v[120:123], v[88:91], v[232:235]
    s_add_u32 m0, s51, 0x2000
    s_add_u32 s52, s48, 0x10180
    buffer_load_dwordx4 v3, s[12:15], s52 offen lds
    v_mfma_f32_16x16x32_bf16 v[236:239], v[120:123], v[92:95], v[236:239]
    v_mfma_f32_16x16x32_bf16 v[240:243], v[124:127], v[80:83], v[240:243]
    v_mfma_f32_16x16x32_bf16 v[244:247], v[124:127], v[84:87], v[244:247]
    v_mfma_f32_16x16x32_bf16 v[248:251], v[124:127], v[88:91], v[248:251]
    v_mfma_f32_16x16x32_bf16 v[252:255], v[124:127], v[92:95], v[252:255]
    s_waitcnt lgkmcnt(0)
    v_mfma_f32_16x16x32_bf16 v[128:131], v[96:99], v[64:67], v[128:131]
    ds_read_b64_tr_b16 v[112:113], v24 offset:16384
    s_add_u32 m0, s51, 0x3000
    s_add_u32 s52, s48, 0x18180
    buffer_load_dwordx4 v3, s[12:15], s52 offen lds
    v_mfma_f32_16x16x32_bf16 v[132:135], v[96:99], v[68:71], v[132:135]
    ds_read_b64_tr_b16 v[114:115], v24 offset:16896
    v_mfma_f32_16x16x32_bf16 v[136:139], v[96:99], v[72:75], v[136:139]
    ds_read_b64_tr_b16 v[116:117], v25 offset:16384
    v_mfma_f32_16x16x32_bf16 v[140:143], v[96:99], v[76:79], v[140:143]
    ds_read_b64_tr_b16 v[118:119], v25 offset:16896
    v_mfma_f32_16x16x32_bf16 v[144:147], v[100:103], v[64:67], v[144:147]
    ds_read_b64_tr_b16 v[120:121], v26 offset:16384
    v_mfma_f32_16x16x32_bf16 v[148:151], v[100:103], v[68:71], v[148:151]
    ds_read_b64_tr_b16 v[122:123], v26 offset:16896
    s_add_u32 m0, s51, 0x4000
    s_add_u32 s52, s49, 0xa8000
    buffer_load_dwordx4 v4, s[16:19], s52 offen lds
    v_mfma_f32_16x16x32_bf16 v[152:155], v[100:103], v[72:75], v[152:155]
    ds_read_b64_tr_b16 v[124:125], v27 offset:16384
    v_mfma_f32_16x16x32_bf16 v[156:159], v[100:103], v[76:79], v[156:159]
    ds_read_b64_tr_b16 v[126:127], v27 offset:16896
    v_mfma_f32_16x16x32_bf16 v[160:163], v[104:107], v[64:67], v[160:163]
    v_mfma_f32_16x16x32_bf16 v[164:167], v[104:107], v[68:71], v[164:167]
    v_mfma_f32_16x16x32_bf16 v[168:171], v[104:107], v[72:75], v[168:171]
    s_add_u32 m0, s51, 0x5000
    s_add_u32 s52, s49, 0xc4000
    buffer_load_dwordx4 v4, s[16:19], s52 offen lds
    v_mfma_f32_16x16x32_bf16 v[172:175], v[104:107], v[76:79], v[172:175]
    v_mfma_f32_16x16x32_bf16 v[176:179], v[108:111], v[64:67], v[176:179]
    v_mfma_f32_16x16x32_bf16 v[180:183], v[108:111], v[68:71], v[180:183]
    v_mfma_f32_16x16x32_bf16 v[184:187], v[108:111], v[72:75], v[184:187]
    v_mfma_f32_16x16x32_bf16 v[188:191], v[108:111], v[76:79], v[188:191]
    s_waitcnt lgkmcnt(0)
    v_mfma_f32_16x16x32_bf16 v[192:195], v[112:115], v[64:67], v[192:195]
    ds_read_b128 v[80:83], v23 offset:0
    ds_read_b128 v[84:87], v23 offset:2048
    s_add_u32 m0, s51, 0x6000
    s_add_u32 s52, s49, 0xa8080
    buffer_load_dwordx4 v4, s[16:19], s52 offen lds
    v_mfma_f32_16x16x32_bf16 v[196:199], v[112:115], v[68:71], v[196:199]
    ds_read_b128 v[88:91], v23 offset:4096
    v_mfma_f32_16x16x32_bf16 v[200:203], v[112:115], v[72:75], v[200:203]
    ds_read_b128 v[92:95], v23 offset:6144
    ds_read_b64_tr_b16 v[96:97], v24 offset:4096
    v_mfma_f32_16x16x32_bf16 v[204:207], v[112:115], v[76:79], v[204:207]
    ds_read_b64_tr_b16 v[98:99], v24 offset:4608
    v_mfma_f32_16x16x32_bf16 v[208:211], v[116:119], v[64:67], v[208:211]
    ds_read_b64_tr_b16 v[100:101], v25 offset:4096
    ds_read_b64_tr_b16 v[102:103], v25 offset:4608
    v_mfma_f32_16x16x32_bf16 v[212:215], v[116:119], v[68:71], v[212:215]
    ds_read_b64_tr_b16 v[104:105], v26 offset:4096
    s_add_u32 m0, s51, 0x7000
    s_add_u32 s52, s49, 0xc4080
    buffer_load_dwordx4 v4, s[16:19], s52 offen lds
    v_mfma_f32_16x16x32_bf16 v[216:219], v[116:119], v[72:75], v[216:219]
    ds_read_b64_tr_b16 v[106:107], v26 offset:4608
    ds_read_b64_tr_b16 v[108:109], v27 offset:4096
    v_mfma_f32_16x16x32_bf16 v[220:223], v[116:119], v[76:79], v[220:223]
    ds_read_b64_tr_b16 v[110:111], v27 offset:4608
    v_mfma_f32_16x16x32_bf16 v[224:227], v[120:123], v[64:67], v[224:227]
    v_mfma_f32_16x16x32_bf16 v[228:231], v[120:123], v[68:71], v[228:231]
    v_mfma_f32_16x16x32_bf16 v[232:235], v[120:123], v[72:75], v[232:235]
    s_add_u32 m0, s51, 0x8000
    s_add_u32 s52, s49, 0xa8000
    buffer_load_dwordx4 v4, s[20:23], s52 offen lds
    v_mfma_f32_16x16x32_bf16 v[236:239], v[120:123], v[76:79], v[236:239]
    v_mfma_f32_16x16x32_bf16 v[240:243], v[124:127], v[64:67], v[240:243]
    v_mfma_f32_16x16x32_bf16 v[244:247], v[124:127], v[68:71], v[244:247]
    v_mfma_f32_16x16x32_bf16 v[248:251], v[124:127], v[72:75], v[248:251]
    v_mfma_f32_16x16x32_bf16 v[252:255], v[124:127], v[76:79], v[252:255]
    s_waitcnt lgkmcnt(0)
    v_mfma_f32_16x16x32_bf16 v[128:131], v[96:99], v[80:83], v[128:131]
    ds_read_b64_tr_b16 v[112:113], v24 offset:20480
    s_add_u32 m0, s51, 0x9000
    s_add_u32 s52, s49, 0xc4000
    buffer_load_dwordx4 v4, s[20:23], s52 offen lds
    v_mfma_f32_16x16x32_bf16 v[132:135], v[96:99], v[84:87], v[132:135]
    ds_read_b64_tr_b16 v[114:115], v24 offset:20992
    v_mfma_f32_16x16x32_bf16 v[136:139], v[96:99], v[88:91], v[136:139]
    ds_read_b64_tr_b16 v[116:117], v25 offset:20480
    v_mfma_f32_16x16x32_bf16 v[140:143], v[96:99], v[92:95], v[140:143]
    ds_read_b64_tr_b16 v[118:119], v25 offset:20992
    v_mfma_f32_16x16x32_bf16 v[144:147], v[100:103], v[80:83], v[144:147]
    ds_read_b64_tr_b16 v[120:121], v26 offset:20480
    v_mfma_f32_16x16x32_bf16 v[148:151], v[100:103], v[84:87], v[148:151]
    ds_read_b64_tr_b16 v[122:123], v26 offset:20992
    s_add_u32 m0, s51, 0xa000
    s_add_u32 s52, s49, 0xa8080
    buffer_load_dwordx4 v4, s[20:23], s52 offen lds
    v_mfma_f32_16x16x32_bf16 v[152:155], v[100:103], v[88:91], v[152:155]
    ds_read_b64_tr_b16 v[124:125], v27 offset:20480
    v_mfma_f32_16x16x32_bf16 v[156:159], v[100:103], v[92:95], v[156:159]
    ds_read_b64_tr_b16 v[126:127], v27 offset:20992
    v_mfma_f32_16x16x32_bf16 v[160:163], v[104:107], v[80:83], v[160:163]
    v_mfma_f32_16x16x32_bf16 v[164:167], v[104:107], v[84:87], v[164:167]
    v_mfma_f32_16x16x32_bf16 v[168:171], v[104:107], v[88:91], v[168:171]
    s_add_u32 m0, s51, 0xb000
    s_add_u32 s52, s49, 0xc4080
    buffer_load_dwordx4 v4, s[20:23], s52 offen lds
    v_mfma_f32_16x16x32_bf16 v[172:175], v[104:107], v[92:95], v[172:175]
    v_mfma_f32_16x16x32_bf16 v[176:179], v[108:111], v[80:83], v[176:179]
    v_mfma_f32_16x16x32_bf16 v[180:183], v[108:111], v[84:87], v[180:183]
    v_mfma_f32_16x16x32_bf16 v[184:187], v[108:111], v[88:91], v[184:187]
    v_mfma_f32_16x16x32_bf16 v[188:191], v[108:111], v[92:95], v[188:191]
    s_waitcnt lgkmcnt(0)
    s_waitcnt vmcnt(12)
    s_barrier
    v_mfma_f32_16x16x32_bf16 v[192:195], v[112:115], v[80:83], v[192:195]
    ds_read_b128 v[64:67], v28 offset:0
    ds_read_b128 v[68:71], v28 offset:2048
    s_add_u32 m0, s51, 0xc000
    s_add_u32 s52, s48, 0x200
    buffer_load_dwordx4 v3, s[12:15], s52 offen lds
    v_mfma_f32_16x16x32_bf16 v[196:199], v[112:115], v[84:87], v[196:199]
    ds_read_b128 v[72:75], v28 offset:4096
    v_mfma_f32_16x16x32_bf16 v[200:203], v[112:115], v[88:91], v[200:203]
    ds_read_b128 v[76:79], v28 offset:6144
    ds_read_b64_tr_b16 v[96:97], v30 offset:0
    v_mfma_f32_16x16x32_bf16 v[204:207], v[112:115], v[92:95], v[204:207]
    ds_read_b64_tr_b16 v[98:99], v30 offset:512
    v_mfma_f32_16x16x32_bf16 v[208:211], v[116:119], v[80:83], v[208:211]
    ds_read_b64_tr_b16 v[100:101], v31 offset:0
    ds_read_b64_tr_b16 v[102:103], v31 offset:512
    v_mfma_f32_16x16x32_bf16 v[212:215], v[116:119], v[84:87], v[212:215]
    ds_read_b64_tr_b16 v[104:105], v32 offset:0
    s_add_u32 m0, s51, 0xd000
    s_add_u32 s52, s48, 0x8200
    buffer_load_dwordx4 v3, s[12:15], s52 offen lds
    v_mfma_f32_16x16x32_bf16 v[216:219], v[116:119], v[88:91], v[216:219]
    ds_read_b64_tr_b16 v[106:107], v32 offset:512
    ds_read_b64_tr_b16 v[108:109], v33 offset:0
    v_mfma_f32_16x16x32_bf16 v[220:223], v[116:119], v[92:95], v[220:223]
    ds_read_b64_tr_b16 v[110:111], v33 offset:512
    v_mfma_f32_16x16x32_bf16 v[224:227], v[120:123], v[80:83], v[224:227]
    v_mfma_f32_16x16x32_bf16 v[228:231], v[120:123], v[84:87], v[228:231]
    v_mfma_f32_16x16x32_bf16 v[232:235], v[120:123], v[88:91], v[232:235]
    s_add_u32 m0, s51, 0xe000
    s_add_u32 s52, s48, 0x10200
    buffer_load_dwordx4 v3, s[12:15], s52 offen lds
    v_mfma_f32_16x16x32_bf16 v[236:239], v[120:123], v[92:95], v[236:239]
    v_mfma_f32_16x16x32_bf16 v[240:243], v[124:127], v[80:83], v[240:243]
    v_mfma_f32_16x16x32_bf16 v[244:247], v[124:127], v[84:87], v[244:247]
    v_mfma_f32_16x16x32_bf16 v[248:251], v[124:127], v[88:91], v[248:251]
    v_mfma_f32_16x16x32_bf16 v[252:255], v[124:127], v[92:95], v[252:255]
    s_waitcnt lgkmcnt(0)
    v_mfma_f32_16x16x32_bf16 v[128:131], v[96:99], v[64:67], v[128:131]
    ds_read_b64_tr_b16 v[112:113], v30 offset:16384
    s_add_u32 m0, s51, 0xf000
    s_add_u32 s52, s48, 0x18200
    buffer_load_dwordx4 v3, s[12:15], s52 offen lds
    v_mfma_f32_16x16x32_bf16 v[132:135], v[96:99], v[68:71], v[132:135]
    ds_read_b64_tr_b16 v[114:115], v30 offset:16896
    v_mfma_f32_16x16x32_bf16 v[136:139], v[96:99], v[72:75], v[136:139]
    ds_read_b64_tr_b16 v[116:117], v31 offset:16384
    v_mfma_f32_16x16x32_bf16 v[140:143], v[96:99], v[76:79], v[140:143]
    ds_read_b64_tr_b16 v[118:119], v31 offset:16896
    v_mfma_f32_16x16x32_bf16 v[144:147], v[100:103], v[64:67], v[144:147]
    ds_read_b64_tr_b16 v[120:121], v32 offset:16384
    v_mfma_f32_16x16x32_bf16 v[148:151], v[100:103], v[68:71], v[148:151]
    ds_read_b64_tr_b16 v[122:123], v32 offset:16896
    s_add_u32 m0, s51, 0x10000
    s_add_u32 s52, s49, 0xe0000
    buffer_load_dwordx4 v4, s[16:19], s52 offen lds
    v_mfma_f32_16x16x32_bf16 v[152:155], v[100:103], v[72:75], v[152:155]
    ds_read_b64_tr_b16 v[124:125], v33 offset:16384
    v_mfma_f32_16x16x32_bf16 v[156:159], v[100:103], v[76:79], v[156:159]
    ds_read_b64_tr_b16 v[126:127], v33 offset:16896
    v_mfma_f32_16x16x32_bf16 v[160:163], v[104:107], v[64:67], v[160:163]
    v_mfma_f32_16x16x32_bf16 v[164:167], v[104:107], v[68:71], v[164:167]
    v_mfma_f32_16x16x32_bf16 v[168:171], v[104:107], v[72:75], v[168:171]
    s_add_u32 m0, s51, 0x11000
    s_add_u32 s52, s49, 0xfc000
    buffer_load_dwordx4 v4, s[16:19], s52 offen lds
    v_mfma_f32_16x16x32_bf16 v[172:175], v[104:107], v[76:79], v[172:175]
    v_mfma_f32_16x16x32_bf16 v[176:179], v[108:111], v[64:67], v[176:179]
    v_mfma_f32_16x16x32_bf16 v[180:183], v[108:111], v[68:71], v[180:183]
    v_mfma_f32_16x16x32_bf16 v[184:187], v[108:111], v[72:75], v[184:187]
    v_mfma_f32_16x16x32_bf16 v[188:191], v[108:111], v[76:79], v[188:191]
    s_waitcnt lgkmcnt(0)
    v_mfma_f32_16x16x32_bf16 v[192:195], v[112:115], v[64:67], v[192:195]
    ds_read_b128 v[80:83], v29 offset:0
    ds_read_b128 v[84:87], v29 offset:2048
    s_add_u32 m0, s51, 0x12000
    s_add_u32 s52, s49, 0xe0080
    buffer_load_dwordx4 v4, s[16:19], s52 offen lds
    v_mfma_f32_16x16x32_bf16 v[196:199], v[112:115], v[68:71], v[196:199]
    ds_read_b128 v[88:91], v29 offset:4096
    v_mfma_f32_16x16x32_bf16 v[200:203], v[112:115], v[72:75], v[200:203]
    ds_read_b128 v[92:95], v29 offset:6144
    ds_read_b64_tr_b16 v[96:97], v30 offset:4096
    v_mfma_f32_16x16x32_bf16 v[204:207], v[112:115], v[76:79], v[204:207]
    ds_read_b64_tr_b16 v[98:99], v30 offset:4608
    v_mfma_f32_16x16x32_bf16 v[208:211], v[116:119], v[64:67], v[208:211]
    ds_read_b64_tr_b16 v[100:101], v31 offset:4096
    ds_read_b64_tr_b16 v[102:103], v31 offset:4608
    v_mfma_f32_16x16x32_bf16 v[212:215], v[116:119], v[68:71], v[212:215]
    ds_read_b64_tr_b16 v[104:105], v32 offset:4096
    s_add_u32 m0, s51, 0x13000
    s_add_u32 s52, s49, 0xfc080
    buffer_load_dwordx4 v4, s[16:19], s52 offen lds
    v_mfma_f32_16x16x32_bf16 v[216:219], v[116:119], v[72:75], v[216:219]
    ds_read_b64_tr_b16 v[106:107], v32 offset:4608
    ds_read_b64_tr_b16 v[108:109], v33 offset:4096
    v_mfma_f32_16x16x32_bf16 v[220:223], v[116:119], v[76:79], v[220:223]
    ds_read_b64_tr_b16 v[110:111], v33 offset:4608
    v_mfma_f32_16x16x32_bf16 v[224:227], v[120:123], v[64:67], v[224:227]
    v_mfma_f32_16x16x32_bf16 v[228:231], v[120:123], v[68:71], v[228:231]
    v_mfma_f32_16x16x32_bf16 v[232:235], v[120:123], v[72:75], v[232:235]
    s_add_u32 m0, s51, 0x14000
    s_add_u32 s52, s49, 0xe0000
    buffer_load_dwordx4 v4, s[20:23], s52 offen lds
    v_mfma_f32_16x16x32_bf16 v[236:239], v[120:123], v[76:79], v[236:239]
    v_mfma_f32_16x16x32_bf16 v[240:243], v[124:127], v[64:67], v[240:243]
    v_mfma_f32_16x16x32_bf16 v[244:247], v[124:127], v[68:71], v[244:247]
    v_mfma_f32_16x16x32_bf16 v[248:251], v[124:127], v[72:75], v[248:251]
    v_mfma_f32_16x16x32_bf16 v[252:255], v[124:127], v[76:79], v[252:255]
    s_waitcnt lgkmcnt(0)
    v_mfma_f32_16x16x32_bf16 v[128:131], v[96:99], v[80:83], v[128:131]
    ds_read_b64_tr_b16 v[112:113], v30 offset:20480
    s_add_u32 m0, s51, 0x15000
    s_add_u32 s52, s49, 0xfc000
    buffer_load_dwordx4 v4, s[20:23], s52 offen lds
    v_mfma_f32_16x16x32_bf16 v[132:135], v[96:99], v[84:87], v[132:135]
    ds_read_b64_tr_b16 v[114:115], v30 offset:20992
    v_mfma_f32_16x16x32_bf16 v[136:139], v[96:99], v[88:91], v[136:139]
    ds_read_b64_tr_b16 v[116:117], v31 offset:20480
    v_mfma_f32_16x16x32_bf16 v[140:143], v[96:99], v[92:95], v[140:143]
    ds_read_b64_tr_b16 v[118:119], v31 offset:20992
    v_mfma_f32_16x16x32_bf16 v[144:147], v[100:103], v[80:83], v[144:147]
    ds_read_b64_tr_b16 v[120:121], v32 offset:20480
    v_mfma_f32_16x16x32_bf16 v[148:151], v[100:103], v[84:87], v[148:151]
    ds_read_b64_tr_b16 v[122:123], v32 offset:20992
    s_add_u32 m0, s51, 0x16000
    s_add_u32 s52, s49, 0xe0080
    buffer_load_dwordx4 v4, s[20:23], s52 offen lds
    v_mfma_f32_16x16x32_bf16 v[152:155], v[100:103], v[88:91], v[152:155]
    ds_read_b64_tr_b16 v[124:125], v33 offset:20480
    v_mfma_f32_16x16x32_bf16 v[156:159], v[100:103], v[92:95], v[156:159]
    ds_read_b64_tr_b16 v[126:127], v33 offset:20992
    v_mfma_f32_16x16x32_bf16 v[160:163], v[104:107], v[80:83], v[160:163]
    v_mfma_f32_16x16x32_bf16 v[164:167], v[104:107], v[84:87], v[164:167]
    v_mfma_f32_16x16x32_bf16 v[168:171], v[104:107], v[88:91], v[168:171]
    s_add_u32 m0, s51, 0x17000
    s_add_u32 s52, s49, 0xfc080
    buffer_load_dwordx4 v4, s[20:23], s52 offen lds
    v_mfma_f32_16x16x32_bf16 v[172:175], v[104:107], v[92:95], v[172:175]
    v_mfma_f32_16x16x32_bf16 v[176:179], v[108:111], v[80:83], v[176:179]
    v_mfma_f32_16x16x32_bf16 v[180:183], v[108:111], v[84:87], v[180:183]
    v_mfma_f32_16x16x32_bf16 v[184:187], v[108:111], v[88:91], v[184:187]
    v_mfma_f32_16x16x32_bf16 v[188:191], v[108:111], v[92:95], v[188:191]
    s_waitcnt lgkmcnt(0)
    s_waitcnt vmcnt(12)
    s_barrier
    v_mfma_f32_16x16x32_bf16 v[192:195], v[112:115], v[80:83], v[192:195]
    ds_read_b128 v[64:67], v16 offset:0
    ds_read_b128 v[68:71], v16 offset:2048
    s_add_u32 m0, s51, 0x18000
    s_add_u32 s52, s48, 0x280
    buffer_load_dwordx4 v3, s[12:15], s52 offen lds
    v_mfma_f32_16x16x32_bf16 v[196:199], v[112:115], v[84:87], v[196:199]
    ds_read_b128 v[72:75], v16 offset:4096
    v_mfma_f32_16x16x32_bf16 v[200:203], v[112:115], v[88:91], v[200:203]
    ds_read_b128 v[76:79], v16 offset:6144
    ds_read_b64_tr_b16 v[96:97], v18 offset:0
    v_mfma_f32_16x16x32_bf16 v[204:207], v[112:115], v[92:95], v[204:207]
    ds_read_b64_tr_b16 v[98:99], v18 offset:512
    v_mfma_f32_16x16x32_bf16 v[208:211], v[116:119], v[80:83], v[208:211]
    ds_read_b64_tr_b16 v[100:101], v19 offset:0
    ds_read_b64_tr_b16 v[102:103], v19 offset:512
    v_mfma_f32_16x16x32_bf16 v[212:215], v[116:119], v[84:87], v[212:215]
    ds_read_b64_tr_b16 v[104:105], v20 offset:0
    s_add_u32 m0, s51, 0x19000
    s_add_u32 s52, s48, 0x8280
    buffer_load_dwordx4 v3, s[12:15], s52 offen lds
    v_mfma_f32_16x16x32_bf16 v[216:219], v[116:119], v[88:91], v[216:219]
    ds_read_b64_tr_b16 v[106:107], v20 offset:512
    ds_read_b64_tr_b16 v[108:109], v21 offset:0
    v_mfma_f32_16x16x32_bf16 v[220:223], v[116:119], v[92:95], v[220:223]
    ds_read_b64_tr_b16 v[110:111], v21 offset:512
    v_mfma_f32_16x16x32_bf16 v[224:227], v[120:123], v[80:83], v[224:227]
    v_mfma_f32_16x16x32_bf16 v[228:231], v[120:123], v[84:87], v[228:231]
    v_mfma_f32_16x16x32_bf16 v[232:235], v[120:123], v[88:91], v[232:235]
    s_add_u32 m0, s51, 0x1a000
    s_add_u32 s52, s48, 0x10280
    buffer_load_dwordx4 v3, s[12:15], s52 offen lds
    v_mfma_f32_16x16x32_bf16 v[236:239], v[120:123], v[92:95], v[236:239]
    v_mfma_f32_16x16x32_bf16 v[240:243], v[124:127], v[80:83], v[240:243]
    v_mfma_f32_16x16x32_bf16 v[244:247], v[124:127], v[84:87], v[244:247]
    v_mfma_f32_16x16x32_bf16 v[248:251], v[124:127], v[88:91], v[248:251]
    v_mfma_f32_16x16x32_bf16 v[252:255], v[124:127], v[92:95], v[252:255]
    s_waitcnt lgkmcnt(0)
    v_mfma_f32_16x16x32_bf16 v[128:131], v[96:99], v[64:67], v[128:131]
    ds_read_b64_tr_b16 v[112:113], v18 offset:16384
    s_add_u32 m0, s51, 0x1b000
    s_add_u32 s52, s48, 0x18280
    buffer_load_dwordx4 v3, s[12:15], s52 offen lds
    v_mfma_f32_16x16x32_bf16 v[132:135], v[96:99], v[68:71], v[132:135]
    ds_read_b64_tr_b16 v[114:115], v18 offset:16896
    v_mfma_f32_16x16x32_bf16 v[136:139], v[96:99], v[72:75], v[136:139]
    ds_read_b64_tr_b16 v[116:117], v19 offset:16384
    v_mfma_f32_16x16x32_bf16 v[140:143], v[96:99], v[76:79], v[140:143]
    ds_read_b64_tr_b16 v[118:119], v19 offset:16896
    v_mfma_f32_16x16x32_bf16 v[144:147], v[100:103], v[64:67], v[144:147]
    ds_read_b64_tr_b16 v[120:121], v20 offset:16384
    v_mfma_f32_16x16x32_bf16 v[148:151], v[100:103], v[68:71], v[148:151]
    ds_read_b64_tr_b16 v[122:123], v20 offset:16896
    s_add_u32 m0, s51, 0x1c000
    s_add_u32 s52, s49, 0x118000
    buffer_load_dwordx4 v4, s[16:19], s52 offen lds
    v_mfma_f32_16x16x32_bf16 v[152:155], v[100:103], v[72:75], v[152:155]
    ds_read_b64_tr_b16 v[124:125], v21 offset:16384
    v_mfma_f32_16x16x32_bf16 v[156:159], v[100:103], v[76:79], v[156:159]
    ds_read_b64_tr_b16 v[126:127], v21 offset:16896
    v_mfma_f32_16x16x32_bf16 v[160:163], v[104:107], v[64:67], v[160:163]
    v_mfma_f32_16x16x32_bf16 v[164:167], v[104:107], v[68:71], v[164:167]
    v_mfma_f32_16x16x32_bf16 v[168:171], v[104:107], v[72:75], v[168:171]
    s_add_u32 m0, s51, 0x1d000
    s_add_u32 s52, s49, 0x134000
    buffer_load_dwordx4 v4, s[16:19], s52 offen lds
    v_mfma_f32_16x16x32_bf16 v[172:175], v[104:107], v[76:79], v[172:175]
    v_mfma_f32_16x16x32_bf16 v[176:179], v[108:111], v[64:67], v[176:179]
    v_mfma_f32_16x16x32_bf16 v[180:183], v[108:111], v[68:71], v[180:183]
    v_mfma_f32_16x16x32_bf16 v[184:187], v[108:111], v[72:75], v[184:187]
    v_mfma_f32_16x16x32_bf16 v[188:191], v[108:111], v[76:79], v[188:191]
    s_waitcnt lgkmcnt(0)
    v_mfma_f32_16x16x32_bf16 v[192:195], v[112:115], v[64:67], v[192:195]
    ds_read_b128 v[80:83], v17 offset:0
    ds_read_b128 v[84:87], v17 offset:2048
    s_add_u32 m0, s51, 0x1e000
    s_add_u32 s52, s49, 0x118080
    buffer_load_dwordx4 v4, s[16:19], s52 offen lds
    v_mfma_f32_16x16x32_bf16 v[196:199], v[112:115], v[68:71], v[196:199]
    ds_read_b128 v[88:91], v17 offset:4096
    v_mfma_f32_16x16x32_bf16 v[200:203], v[112:115], v[72:75], v[200:203]
    ds_read_b128 v[92:95], v17 offset:6144
    ds_read_b64_tr_b16 v[96:97], v18 offset:4096
    v_mfma_f32_16x16x32_bf16 v[204:207], v[112:115], v[76:79], v[204:207]
    ds_read_b64_tr_b16 v[98:99], v18 offset:4608
    v_mfma_f32_16x16x32_bf16 v[208:211], v[116:119], v[64:67], v[208:211]
    ds_read_b64_tr_b16 v[100:101], v19 offset:4096
    ds_read_b64_tr_b16 v[102:103], v19 offset:4608
    v_mfma_f32_16x16x32_bf16 v[212:215], v[116:119], v[68:71], v[212:215]
    ds_read_b64_tr_b16 v[104:105], v20 offset:4096
    s_add_u32 m0, s51, 0x1f000
    s_add_u32 s52, s49, 0x134080
    buffer_load_dwordx4 v4, s[16:19], s52 offen lds
    v_mfma_f32_16x16x32_bf16 v[216:219], v[116:119], v[72:75], v[216:219]
    ds_read_b64_tr_b16 v[106:107], v20 offset:4608
    ds_read_b64_tr_b16 v[108:109], v21 offset:4096
    v_mfma_f32_16x16x32_bf16 v[220:223], v[116:119], v[76:79], v[220:223]
    ds_read_b64_tr_b16 v[110:111], v21 offset:4608
    v_mfma_f32_16x16x32_bf16 v[224:227], v[120:123], v[64:67], v[224:227]
    v_mfma_f32_16x16x32_bf16 v[228:231], v[120:123], v[68:71], v[228:231]
    v_mfma_f32_16x16x32_bf16 v[232:235], v[120:123], v[72:75], v[232:235]
    s_add_u32 m0, s51, 0x20000
    s_add_u32 s52, s49, 0x118000
    buffer_load_dwordx4 v4, s[20:23], s52 offen lds
    v_mfma_f32_16x16x32_bf16 v[236:239], v[120:123], v[76:79], v[236:239]
    v_mfma_f32_16x16x32_bf16 v[240:243], v[124:127], v[64:67], v[240:243]
    v_mfma_f32_16x16x32_bf16 v[244:247], v[124:127], v[68:71], v[244:247]
    v_mfma_f32_16x16x32_bf16 v[248:251], v[124:127], v[72:75], v[248:251]
    v_mfma_f32_16x16x32_bf16 v[252:255], v[124:127], v[76:79], v[252:255]
    s_waitcnt lgkmcnt(0)
    v_mfma_f32_16x16x32_bf16 v[128:131], v[96:99], v[80:83], v[128:131]
    ds_read_b64_tr_b16 v[112:113], v18 offset:20480
    s_add_u32 m0, s51, 0x21000
    s_add_u32 s52, s49, 0x134000
    buffer_load_dwordx4 v4, s[20:23], s52 offen lds
    v_mfma_f32_16x16x32_bf16 v[132:135], v[96:99], v[84:87], v[132:135]
    ds_read_b64_tr_b16 v[114:115], v18 offset:20992
    v_mfma_f32_16x16x32_bf16 v[136:139], v[96:99], v[88:91], v[136:139]
    ds_read_b64_tr_b16 v[116:117], v19 offset:20480
    v_mfma_f32_16x16x32_bf16 v[140:143], v[96:99], v[92:95], v[140:143]
    ds_read_b64_tr_b16 v[118:119], v19 offset:20992
    v_mfma_f32_16x16x32_bf16 v[144:147], v[100:103], v[80:83], v[144:147]
    ds_read_b64_tr_b16 v[120:121], v20 offset:20480
    v_mfma_f32_16x16x32_bf16 v[148:151], v[100:103], v[84:87], v[148:151]
    ds_read_b64_tr_b16 v[122:123], v20 offset:20992
    s_add_u32 m0, s51, 0x22000
    s_add_u32 s52, s49, 0x118080
    buffer_load_dwordx4 v4, s[20:23], s52 offen lds
    v_mfma_f32_16x16x32_bf16 v[152:155], v[100:103], v[88:91], v[152:155]
    ds_read_b64_tr_b16 v[124:125], v21 offset:20480
    v_mfma_f32_16x16x32_bf16 v[156:159], v[100:103], v[92:95], v[156:159]
    ds_read_b64_tr_b16 v[126:127], v21 offset:20992
    v_mfma_f32_16x16x32_bf16 v[160:163], v[104:107], v[80:83], v[160:163]
    v_mfma_f32_16x16x32_bf16 v[164:167], v[104:107], v[84:87], v[164:167]
    v_mfma_f32_16x16x32_bf16 v[168:171], v[104:107], v[88:91], v[168:171]
    s_add_u32 m0, s51, 0x23000
    s_add_u32 s52, s49, 0x134080
    buffer_load_dwordx4 v4, s[20:23], s52 offen lds
    v_mfma_f32_16x16x32_bf16 v[172:175], v[104:107], v[92:95], v[172:175]
    v_mfma_f32_16x16x32_bf16 v[176:179], v[108:111], v[80:83], v[176:179]
    v_mfma_f32_16x16x32_bf16 v[180:183], v[108:111], v[84:87], v[180:183]
    v_mfma_f32_16x16x32_bf16 v[184:187], v[108:111], v[88:91], v[184:187]
    v_mfma_f32_16x16x32_bf16 v[188:191], v[108:111], v[92:95], v[188:191]
    s_waitcnt lgkmcnt(0)
    s_waitcnt vmcnt(12)
    s_barrier
    v_mfma_f32_16x16x32_bf16 v[192:195], v[112:115], v[80:83], v[192:195]
    ds_read_b128 v[64:67], v22 offset:0
    ds_read_b128 v[68:71], v22 offset:2048
    s_add_u32 m0, s51, 0x0
    s_add_u32 s52, s48, 0x300
    buffer_load_dwordx4 v3, s[12:15], s52 offen lds
    v_mfma_f32_16x16x32_bf16 v[196:199], v[112:115], v[84:87], v[196:199]
    ds_read_b128 v[72:75], v22 offset:4096
    v_mfma_f32_16x16x32_bf16 v[200:203], v[112:115], v[88:91], v[200:203]
    ds_read_b128 v[76:79], v22 offset:6144
    ds_read_b64_tr_b16 v[96:97], v24 offset:0
    v_mfma_f32_16x16x32_bf16 v[204:207], v[112:115], v[92:95], v[204:207]
    ds_read_b64_tr_b16 v[98:99], v24 offset:512
    v_mfma_f32_16x16x32_bf16 v[208:211], v[116:119], v[80:83], v[208:211]
    ds_read_b64_tr_b16 v[100:101], v25 offset:0
    ds_read_b64_tr_b16 v[102:103], v25 offset:512
    v_mfma_f32_16x16x32_bf16 v[212:215], v[116:119], v[84:87], v[212:215]
    ds_read_b64_tr_b16 v[104:105], v26 offset:0
    s_add_u32 m0, s51, 0x1000
    s_add_u32 s52, s48, 0x8300
    buffer_load_dwordx4 v3, s[12:15], s52 offen lds
    v_mfma_f32_16x16x32_bf16 v[216:219], v[116:119], v[88:91], v[216:219]
    ds_read_b64_tr_b16 v[106:107], v26 offset:512
    ds_read_b64_tr_b16 v[108:109], v27 offset:0
    v_mfma_f32_16x16x32_bf16 v[220:223], v[116:119], v[92:95], v[220:223]
    ds_read_b64_tr_b16 v[110:111], v27 offset:512
    v_mfma_f32_16x16x32_bf16 v[224:227], v[120:123], v[80:83], v[224:227]
    v_mfma_f32_16x16x32_bf16 v[228:231], v[120:123], v[84:87], v[228:231]
    v_mfma_f32_16x16x32_bf16 v[232:235], v[120:123], v[88:91], v[232:235]
    s_add_u32 m0, s51, 0x2000
    s_add_u32 s52, s48, 0x10300
    buffer_load_dwordx4 v3, s[12:15], s52 offen lds
    v_mfma_f32_16x16x32_bf16 v[236:239], v[120:123], v[92:95], v[236:239]
    v_mfma_f32_16x16x32_bf16 v[240:243], v[124:127], v[80:83], v[240:243]
    v_mfma_f32_16x16x32_bf16 v[244:247], v[124:127], v[84:87], v[244:247]
    v_mfma_f32_16x16x32_bf16 v[248:251], v[124:127], v[88:91], v[248:251]
    v_mfma_f32_16x16x32_bf16 v[252:255], v[124:127], v[92:95], v[252:255]
    s_waitcnt lgkmcnt(0)
    v_mfma_f32_16x16x32_bf16 v[128:131], v[96:99], v[64:67], v[128:131]
    ds_read_b64_tr_b16 v[112:113], v24 offset:16384
    s_add_u32 m0, s51, 0x3000
    s_add_u32 s52, s48, 0x18300
    buffer_load_dwordx4 v3, s[12:15], s52 offen lds
    v_mfma_f32_16x16x32_bf16 v[132:135], v[96:99], v[68:71], v[132:135]
    ds_read_b64_tr_b16 v[114:115], v24 offset:16896
    v_mfma_f32_16x16x32_bf16 v[136:139], v[96:99], v[72:75], v[136:139]
    ds_read_b64_tr_b16 v[116:117], v25 offset:16384
    v_mfma_f32_16x16x32_bf16 v[140:143], v[96:99], v[76:79], v[140:143]
    ds_read_b64_tr_b16 v[118:119], v25 offset:16896
    v_mfma_f32_16x16x32_bf16 v[144:147], v[100:103], v[64:67], v[144:147]
    ds_read_b64_tr_b16 v[120:121], v26 offset:16384
    v_mfma_f32_16x16x32_bf16 v[148:151], v[100:103], v[68:71], v[148:151]
    ds_read_b64_tr_b16 v[122:123], v26 offset:16896
    s_add_u32 m0, s51, 0x4000
    s_add_u32 s52, s49, 0x150000
    buffer_load_dwordx4 v4, s[16:19], s52 offen lds
    v_mfma_f32_16x16x32_bf16 v[152:155], v[100:103], v[72:75], v[152:155]
    ds_read_b64_tr_b16 v[124:125], v27 offset:16384
    v_mfma_f32_16x16x32_bf16 v[156:159], v[100:103], v[76:79], v[156:159]
    ds_read_b64_tr_b16 v[126:127], v27 offset:16896
    v_mfma_f32_16x16x32_bf16 v[160:163], v[104:107], v[64:67], v[160:163]
    v_mfma_f32_16x16x32_bf16 v[164:167], v[104:107], v[68:71], v[164:167]
    v_mfma_f32_16x16x32_bf16 v[168:171], v[104:107], v[72:75], v[168:171]
    s_add_u32 m0, s51, 0x5000
    s_add_u32 s52, s49, 0x16c000
    buffer_load_dwordx4 v4, s[16:19], s52 offen lds
    v_mfma_f32_16x16x32_bf16 v[172:175], v[104:107], v[76:79], v[172:175]
    v_mfma_f32_16x16x32_bf16 v[176:179], v[108:111], v[64:67], v[176:179]
    v_mfma_f32_16x16x32_bf16 v[180:183], v[108:111], v[68:71], v[180:183]
    v_mfma_f32_16x16x32_bf16 v[184:187], v[108:111], v[72:75], v[184:187]
    v_mfma_f32_16x16x32_bf16 v[188:191], v[108:111], v[76:79], v[188:191]
    s_waitcnt lgkmcnt(0)
    v_mfma_f32_16x16x32_bf16 v[192:195], v[112:115], v[64:67], v[192:195]
    ds_read_b128 v[80:83], v23 offset:0
    ds_read_b128 v[84:87], v23 offset:2048
    s_add_u32 m0, s51, 0x6000
    s_add_u32 s52, s49, 0x150080
    buffer_load_dwordx4 v4, s[16:19], s52 offen lds
    v_mfma_f32_16x16x32_bf16 v[196:199], v[112:115], v[68:71], v[196:199]
    ds_read_b128 v[88:91], v23 offset:4096
    v_mfma_f32_16x16x32_bf16 v[200:203], v[112:115], v[72:75], v[200:203]
    ds_read_b128 v[92:95], v23 offset:6144
    ds_read_b64_tr_b16 v[96:97], v24 offset:4096
    v_mfma_f32_16x16x32_bf16 v[204:207], v[112:115], v[76:79], v[204:207]
    ds_read_b64_tr_b16 v[98:99], v24 offset:4608
    v_mfma_f32_16x16x32_bf16 v[208:211], v[116:119], v[64:67], v[208:211]
    ds_read_b64_tr_b16 v[100:101], v25 offset:4096
    ds_read_b64_tr_b16 v[102:103], v25 offset:4608
    v_mfma_f32_16x16x32_bf16 v[212:215], v[116:119], v[68:71], v[212:215]
    ds_read_b64_tr_b16 v[104:105], v26 offset:4096
    s_add_u32 m0, s51, 0x7000
    s_add_u32 s52, s49, 0x16c080
    buffer_load_dwordx4 v4, s[16:19], s52 offen lds
    v_mfma_f32_16x16x32_bf16 v[216:219], v[116:119], v[72:75], v[216:219]
    ds_read_b64_tr_b16 v[106:107], v26 offset:4608
    ds_read_b64_tr_b16 v[108:109], v27 offset:4096
    v_mfma_f32_16x16x32_bf16 v[220:223], v[116:119], v[76:79], v[220:223]
    ds_read_b64_tr_b16 v[110:111], v27 offset:4608
    v_mfma_f32_16x16x32_bf16 v[224:227], v[120:123], v[64:67], v[224:227]
    v_mfma_f32_16x16x32_bf16 v[228:231], v[120:123], v[68:71], v[228:231]
    v_mfma_f32_16x16x32_bf16 v[232:235], v[120:123], v[72:75], v[232:235]
    s_add_u32 m0, s51, 0x8000
    s_add_u32 s52, s49, 0x150000
    buffer_load_dwordx4 v4, s[20:23], s52 offen lds
    v_mfma_f32_16x16x32_bf16 v[236:239], v[120:123], v[76:79], v[236:239]
    v_mfma_f32_16x16x32_bf16 v[240:243], v[124:127], v[64:67], v[240:243]
    v_mfma_f32_16x16x32_bf16 v[244:247], v[124:127], v[68:71], v[244:247]
    v_mfma_f32_16x16x32_bf16 v[248:251], v[124:127], v[72:75], v[248:251]
    v_mfma_f32_16x16x32_bf16 v[252:255], v[124:127], v[76:79], v[252:255]
    s_waitcnt lgkmcnt(0)
    v_mfma_f32_16x16x32_bf16 v[128:131], v[96:99], v[80:83], v[128:131]
    ds_read_b64_tr_b16 v[112:113], v24 offset:20480
    s_add_u32 m0, s51, 0x9000
    s_add_u32 s52, s49, 0x16c000
    buffer_load_dwordx4 v4, s[20:23], s52 offen lds
    v_mfma_f32_16x16x32_bf16 v[132:135], v[96:99], v[84:87], v[132:135]
    ds_read_b64_tr_b16 v[114:115], v24 offset:20992
    v_mfma_f32_16x16x32_bf16 v[136:139], v[96:99], v[88:91], v[136:139]
    ds_read_b64_tr_b16 v[116:117], v25 offset:20480
    v_mfma_f32_16x16x32_bf16 v[140:143], v[96:99], v[92:95], v[140:143]
    ds_read_b64_tr_b16 v[118:119], v25 offset:20992
    v_mfma_f32_16x16x32_bf16 v[144:147], v[100:103], v[80:83], v[144:147]
    ds_read_b64_tr_b16 v[120:121], v26 offset:20480
    v_mfma_f32_16x16x32_bf16 v[148:151], v[100:103], v[84:87], v[148:151]
    ds_read_b64_tr_b16 v[122:123], v26 offset:20992
    s_add_u32 m0, s51, 0xa000
    s_add_u32 s52, s49, 0x150080
    buffer_load_dwordx4 v4, s[20:23], s52 offen lds
    v_mfma_f32_16x16x32_bf16 v[152:155], v[100:103], v[88:91], v[152:155]
    ds_read_b64_tr_b16 v[124:125], v27 offset:20480
    v_mfma_f32_16x16x32_bf16 v[156:159], v[100:103], v[92:95], v[156:159]
    ds_read_b64_tr_b16 v[126:127], v27 offset:20992
    v_mfma_f32_16x16x32_bf16 v[160:163], v[104:107], v[80:83], v[160:163]
    v_mfma_f32_16x16x32_bf16 v[164:167], v[104:107], v[84:87], v[164:167]
    v_mfma_f32_16x16x32_bf16 v[168:171], v[104:107], v[88:91], v[168:171]
    s_add_u32 m0, s51, 0xb000
    s_add_u32 s52, s49, 0x16c080
    buffer_load_dwordx4 v4, s[20:23], s52 offen lds
    v_mfma_f32_16x16x32_bf16 v[172:175], v[104:107], v[92:95], v[172:175]
    v_mfma_f32_16x16x32_bf16 v[176:179], v[108:111], v[80:83], v[176:179]
    v_mfma_f32_16x16x32_bf16 v[180:183], v[108:111], v[84:87], v[180:183]
    v_mfma_f32_16x16x32_bf16 v[184:187], v[108:111], v[88:91], v[184:187]
    v_mfma_f32_16x16x32_bf16 v[188:191], v[108:111], v[92:95], v[188:191]
    s_waitcnt lgkmcnt(0)
    s_waitcnt vmcnt(12)
    s_barrier
    v_mfma_f32_16x16x32_bf16 v[192:195], v[112:115], v[80:83], v[192:195]
    ds_read_b128 v[64:67], v28 offset:0
    ds_read_b128 v[68:71], v28 offset:2048
    s_add_u32 m0, s51, 0xc000
    s_add_u32 s52, s48, 0x380
    buffer_load_dwordx4 v3, s[12:15], s52 offen lds
    v_mfma_f32_16x16x32_bf16 v[196:199], v[112:115], v[84:87], v[196:199]
    ds_read_b128 v[72:75], v28 offset:4096
    v_mfma_f32_16x16x32_bf16 v[200:203], v[112:115], v[88:91], v[200:203]
    ds_read_b128 v[76:79], v28 offset:6144
    ds_read_b64_tr_b16 v[96:97], v30 offset:0
    v_mfma_f32_16x16x32_bf16 v[204:207], v[112:115], v[92:95], v[204:207]
    ds_read_b64_tr_b16 v[98:99], v30 offset:512
    v_mfma_f32_16x16x32_bf16 v[208:211], v[116:119], v[80:83], v[208:211]
    ds_read_b64_tr_b16 v[100:101], v31 offset:0
    ds_read_b64_tr_b16 v[102:103], v31 offset:512
    v_mfma_f32_16x16x32_bf16 v[212:215], v[116:119], v[84:87], v[212:215]
    ds_read_b64_tr_b16 v[104:105], v32 offset:0
    s_add_u32 m0, s51, 0xd000
    s_add_u32 s52, s48, 0x8380
    buffer_load_dwordx4 v3, s[12:15], s52 offen lds
    v_mfma_f32_16x16x32_bf16 v[216:219], v[116:119], v[88:91], v[216:219]
    ds_read_b64_tr_b16 v[106:107], v32 offset:512
    ds_read_b64_tr_b16 v[108:109], v33 offset:0
    v_mfma_f32_16x16x32_bf16 v[220:223], v[116:119], v[92:95], v[220:223]
    ds_read_b64_tr_b16 v[110:111], v33 offset:512
    v_mfma_f32_16x16x32_bf16 v[224:227], v[120:123], v[80:83], v[224:227]
    v_mfma_f32_16x16x32_bf16 v[228:231], v[120:123], v[84:87], v[228:231]
    v_mfma_f32_16x16x32_bf16 v[232:235], v[120:123], v[88:91], v[232:235]
    s_add_u32 m0, s51, 0xe000
    s_add_u32 s52, s48, 0x10380
    buffer_load_dwordx4 v3, s[12:15], s52 offen lds
    v_mfma_f32_16x16x32_bf16 v[236:239], v[120:123], v[92:95], v[236:239]
    v_mfma_f32_16x16x32_bf16 v[240:243], v[124:127], v[80:83], v[240:243]
    v_mfma_f32_16x16x32_bf16 v[244:247], v[124:127], v[84:87], v[244:247]
    v_mfma_f32_16x16x32_bf16 v[248:251], v[124:127], v[88:91], v[248:251]
    v_mfma_f32_16x16x32_bf16 v[252:255], v[124:127], v[92:95], v[252:255]
    s_waitcnt lgkmcnt(0)
    v_mfma_f32_16x16x32_bf16 v[128:131], v[96:99], v[64:67], v[128:131]
    ds_read_b64_tr_b16 v[112:113], v30 offset:16384
    s_add_u32 m0, s51, 0xf000
    s_add_u32 s52, s48, 0x18380
    buffer_load_dwordx4 v3, s[12:15], s52 offen lds
    v_mfma_f32_16x16x32_bf16 v[132:135], v[96:99], v[68:71], v[132:135]
    ds_read_b64_tr_b16 v[114:115], v30 offset:16896
    v_mfma_f32_16x16x32_bf16 v[136:139], v[96:99], v[72:75], v[136:139]
    ds_read_b64_tr_b16 v[116:117], v31 offset:16384
    v_mfma_f32_16x16x32_bf16 v[140:143], v[96:99], v[76:79], v[140:143]
    ds_read_b64_tr_b16 v[118:119], v31 offset:16896
    v_mfma_f32_16x16x32_bf16 v[144:147], v[100:103], v[64:67], v[144:147]
    ds_read_b64_tr_b16 v[120:121], v32 offset:16384
    v_mfma_f32_16x16x32_bf16 v[148:151], v[100:103], v[68:71], v[148:151]
    ds_read_b64_tr_b16 v[122:123], v32 offset:16896
    s_add_u32 m0, s51, 0x10000
    s_add_u32 s52, s49, 0x188000
    buffer_load_dwordx4 v4, s[16:19], s52 offen lds
    v_mfma_f32_16x16x32_bf16 v[152:155], v[100:103], v[72:75], v[152:155]
    ds_read_b64_tr_b16 v[124:125], v33 offset:16384
    v_mfma_f32_16x16x32_bf16 v[156:159], v[100:103], v[76:79], v[156:159]
    ds_read_b64_tr_b16 v[126:127], v33 offset:16896
    v_mfma_f32_16x16x32_bf16 v[160:163], v[104:107], v[64:67], v[160:163]
    v_mfma_f32_16x16x32_bf16 v[164:167], v[104:107], v[68:71], v[164:167]
    v_mfma_f32_16x16x32_bf16 v[168:171], v[104:107], v[72:75], v[168:171]
    s_add_u32 m0, s51, 0x11000
    s_add_u32 s52, s49, 0x1a4000
    buffer_load_dwordx4 v4, s[16:19], s52 offen lds
    v_mfma_f32_16x16x32_bf16 v[172:175], v[104:107], v[76:79], v[172:175]
    v_mfma_f32_16x16x32_bf16 v[176:179], v[108:111], v[64:67], v[176:179]
    v_mfma_f32_16x16x32_bf16 v[180:183], v[108:111], v[68:71], v[180:183]
    v_mfma_f32_16x16x32_bf16 v[184:187], v[108:111], v[72:75], v[184:187]
    v_mfma_f32_16x16x32_bf16 v[188:191], v[108:111], v[76:79], v[188:191]
    s_waitcnt lgkmcnt(0)
    v_mfma_f32_16x16x32_bf16 v[192:195], v[112:115], v[64:67], v[192:195]
    ds_read_b128 v[80:83], v29 offset:0
    ds_read_b128 v[84:87], v29 offset:2048
    s_add_u32 m0, s51, 0x12000
    s_add_u32 s52, s49, 0x188080
    buffer_load_dwordx4 v4, s[16:19], s52 offen lds
    v_mfma_f32_16x16x32_bf16 v[196:199], v[112:115], v[68:71], v[196:199]
    ds_read_b128 v[88:91], v29 offset:4096
    v_mfma_f32_16x16x32_bf16 v[200:203], v[112:115], v[72:75], v[200:203]
    ds_read_b128 v[92:95], v29 offset:6144
    ds_read_b64_tr_b16 v[96:97], v30 offset:4096
    v_mfma_f32_16x16x32_bf16 v[204:207], v[112:115], v[76:79], v[204:207]
    ds_read_b64_tr_b16 v[98:99], v30 offset:4608
    v_mfma_f32_16x16x32_bf16 v[208:211], v[116:119], v[64:67], v[208:211]
    ds_read_b64_tr_b16 v[100:101], v31 offset:4096
    ds_read_b64_tr_b16 v[102:103], v31 offset:4608
    v_mfma_f32_16x16x32_bf16 v[212:215], v[116:119], v[68:71], v[212:215]
    ds_read_b64_tr_b16 v[104:105], v32 offset:4096
    s_add_u32 m0, s51, 0x13000
    s_add_u32 s52, s49, 0x1a4080
    buffer_load_dwordx4 v4, s[16:19], s52 offen lds
    v_mfma_f32_16x16x32_bf16 v[216:219], v[116:119], v[72:75], v[216:219]
    ds_read_b64_tr_b16 v[106:107], v32 offset:4608
    ds_read_b64_tr_b16 v[108:109], v33 offset:4096
    v_mfma_f32_16x16x32_bf16 v[220:223], v[116:119], v[76:79], v[220:223]
    ds_read_b64_tr_b16 v[110:111], v33 offset:4608
    v_mfma_f32_16x16x32_bf16 v[224:227], v[120:123], v[64:67], v[224:227]
    v_mfma_f32_16x16x32_bf16 v[228:231], v[120:123], v[68:71], v[228:231]
    v_mfma_f32_16x16x32_bf16 v[232:235], v[120:123], v[72:75], v[232:235]
    s_add_u32 m0, s51, 0x14000
    s_add_u32 s52, s49, 0x188000
    buffer_load_dwordx4 v4, s[20:23], s52 offen lds
    v_mfma_f32_16x16x32_bf16 v[236:239], v[120:123], v[76:79], v[236:239]
    v_mfma_f32_16x16x32_bf16 v[240:243], v[124:127], v[64:67], v[240:243]
    v_mfma_f32_16x16x32_bf16 v[244:247], v[124:127], v[68:71], v[244:247]
    v_mfma_f32_16x16x32_bf16 v[248:251], v[124:127], v[72:75], v[248:251]
    v_mfma_f32_16x16x32_bf16 v[252:255], v[124:127], v[76:79], v[252:255]
    s_waitcnt lgkmcnt(0)
    v_mfma_f32_16x16x32_bf16 v[128:131], v[96:99], v[80:83], v[128:131]
    ds_read_b64_tr_b16 v[112:113], v30 offset:20480
    s_add_u32 m0, s51, 0x15000
    s_add_u32 s52, s49, 0x1a4000
    buffer_load_dwordx4 v4, s[20:23], s52 offen lds
    v_mfma_f32_16x16x32_bf16 v[132:135], v[96:99], v[84:87], v[132:135]
    ds_read_b64_tr_b16 v[114:115], v30 offset:20992
    v_mfma_f32_16x16x32_bf16 v[136:139], v[96:99], v[88:91], v[136:139]
    ds_read_b64_tr_b16 v[116:117], v31 offset:20480
    v_mfma_f32_16x16x32_bf16 v[140:143], v[96:99], v[92:95], v[140:143]
    ds_read_b64_tr_b16 v[118:119], v31 offset:20992
    v_mfma_f32_16x16x32_bf16 v[144:147], v[100:103], v[80:83], v[144:147]
    ds_read_b64_tr_b16 v[120:121], v32 offset:20480
    v_mfma_f32_16x16x32_bf16 v[148:151], v[100:103], v[84:87], v[148:151]
    ds_read_b64_tr_b16 v[122:123], v32 offset:20992
    s_add_u32 m0, s51, 0x16000
    s_add_u32 s52, s49, 0x188080
    buffer_load_dwordx4 v4, s[20:23], s52 offen lds
    v_mfma_f32_16x16x32_bf16 v[152:155], v[100:103], v[88:91], v[152:155]
    ds_read_b64_tr_b16 v[124:125], v33 offset:20480
    v_mfma_f32_16x16x32_bf16 v[156:159], v[100:103], v[92:95], v[156:159]
    ds_read_b64_tr_b16 v[126:127], v33 offset:20992
    v_mfma_f32_16x16x32_bf16 v[160:163], v[104:107], v[80:83], v[160:163]
    v_mfma_f32_16x16x32_bf16 v[164:167], v[104:107], v[84:87], v[164:167]
    v_mfma_f32_16x16x32_bf16 v[168:171], v[104:107], v[88:91], v[168:171]
    s_add_u32 m0, s51, 0x17000
    s_add_u32 s52, s49, 0x1a4080
    buffer_load_dwordx4 v4, s[20:23], s52 offen lds
    v_mfma_f32_16x16x32_bf16 v[172:175], v[104:107], v[92:95], v[172:175]
    v_mfma_f32_16x16x32_bf16 v[176:179], v[108:111], v[80:83], v[176:179]
    v_mfma_f32_16x16x32_bf16 v[180:183], v[108:111], v[84:87], v[180:183]
    v_mfma_f32_16x16x32_bf16 v[184:187], v[108:111], v[88:91], v[184:187]
    v_mfma_f32_16x16x32_bf16 v[188:191], v[108:111], v[92:95], v[188:191]
    s_waitcnt lgkmcnt(0)
    s_waitcnt vmcnt(12)
    s_barrier
    v_mfma_f32_16x16x32_bf16 v[192:195], v[112:115], v[80:83], v[192:195]
    ds_read_b128 v[64:67], v16 offset:0
    ds_read_b128 v[68:71], v16 offset:2048
    v_mfma_f32_16x16x32_bf16 v[196:199], v[112:115], v[84:87], v[196:199]
    ds_read_b128 v[72:75], v16 offset:4096
    v_mfma_f32_16x16x32_bf16 v[200:203], v[112:115], v[88:91], v[200:203]
    ds_read_b128 v[76:79], v16 offset:6144
    ds_read_b64_tr_b16 v[96:97], v18 offset:0
    v_mfma_f32_16x16x32_bf16 v[204:207], v[112:115], v[92:95], v[204:207]
    ds_read_b64_tr_b16 v[98:99], v18 offset:512
    v_mfma_f32_16x16x32_bf16 v[208:211], v[116:119], v[80:83], v[208:211]
    ds_read_b64_tr_b16 v[100:101], v19 offset:0
    ds_read_b64_tr_b16 v[102:103], v19 offset:512
    v_mfma_f32_16x16x32_bf16 v[212:215], v[116:119], v[84:87], v[212:215]
    ds_read_b64_tr_b16 v[104:105], v20 offset:0
    v_mfma_f32_16x16x32_bf16 v[216:219], v[116:119], v[88:91], v[216:219]
    ds_read_b64_tr_b16 v[106:107], v20 offset:512
    ds_read_b64_tr_b16 v[108:109], v21 offset:0
    v_mfma_f32_16x16x32_bf16 v[220:223], v[116:119], v[92:95], v[220:223]
    ds_read_b64_tr_b16 v[110:111], v21 offset:512
    v_mfma_f32_16x16x32_bf16 v[224:227], v[120:123], v[80:83], v[224:227]
    v_mfma_f32_16x16x32_bf16 v[228:231], v[120:123], v[84:87], v[228:231]
    v_mfma_f32_16x16x32_bf16 v[232:235], v[120:123], v[88:91], v[232:235]
    v_mfma_f32_16x16x32_bf16 v[236:239], v[120:123], v[92:95], v[236:239]
    v_mfma_f32_16x16x32_bf16 v[240:243], v[124:127], v[80:83], v[240:243]
    v_mfma_f32_16x16x32_bf16 v[244:247], v[124:127], v[84:87], v[244:247]
    v_mfma_f32_16x16x32_bf16 v[248:251], v[124:127], v[88:91], v[248:251]
    v_mfma_f32_16x16x32_bf16 v[252:255], v[124:127], v[92:95], v[252:255]
    s_waitcnt lgkmcnt(0)
    v_mfma_f32_16x16x32_bf16 v[128:131], v[96:99], v[64:67], v[128:131]
    ds_read_b64_tr_b16 v[112:113], v18 offset:16384
    v_mfma_f32_16x16x32_bf16 v[132:135], v[96:99], v[68:71], v[132:135]
    ds_read_b64_tr_b16 v[114:115], v18 offset:16896
    v_mfma_f32_16x16x32_bf16 v[136:139], v[96:99], v[72:75], v[136:139]
    ds_read_b64_tr_b16 v[116:117], v19 offset:16384
    v_mfma_f32_16x16x32_bf16 v[140:143], v[96:99], v[76:79], v[140:143]
    ds_read_b64_tr_b16 v[118:119], v19 offset:16896
    v_mfma_f32_16x16x32_bf16 v[144:147], v[100:103], v[64:67], v[144:147]
    ds_read_b64_tr_b16 v[120:121], v20 offset:16384
    v_mfma_f32_16x16x32_bf16 v[148:151], v[100:103], v[68:71], v[148:151]
    ds_read_b64_tr_b16 v[122:123], v20 offset:16896
    v_mfma_f32_16x16x32_bf16 v[152:155], v[100:103], v[72:75], v[152:155]
    ds_read_b64_tr_b16 v[124:125], v21 offset:16384
    v_mfma_f32_16x16x32_bf16 v[156:159], v[100:103], v[76:79], v[156:159]
    ds_read_b64_tr_b16 v[126:127], v21 offset:16896
    v_mfma_f32_16x16x32_bf16 v[160:163], v[104:107], v[64:67], v[160:163]
    v_mfma_f32_16x16x32_bf16 v[164:167], v[104:107], v[68:71], v[164:167]
    v_mfma_f32_16x16x32_bf16 v[168:171], v[104:107], v[72:75], v[168:171]
    v_mfma_f32_16x16x32_bf16 v[172:175], v[104:107], v[76:79], v[172:175]
    v_mfma_f32_16x16x32_bf16 v[176:179], v[108:111], v[64:67], v[176:179]
    v_mfma_f32_16x16x32_bf16 v[180:183], v[108:111], v[68:71], v[180:183]
    v_mfma_f32_16x16x32_bf16 v[184:187], v[108:111], v[72:75], v[184:187]
    v_mfma_f32_16x16x32_bf16 v[188:191], v[108:111], v[76:79], v[188:191]
    s_waitcnt lgkmcnt(0)
    v_mfma_f32_16x16x32_bf16 v[192:195], v[112:115], v[64:67], v[192:195]
    ds_read_b128 v[80:83], v17 offset:0
    ds_read_b128 v[84:87], v17 offset:2048
    v_mfma_f32_16x16x32_bf16 v[196:199], v[112:115], v[68:71], v[196:199]
    ds_read_b128 v[88:91], v17 offset:4096
    v_mfma_f32_16x16x32_bf16 v[200:203], v[112:115], v[72:75], v[200:203]
    ds_read_b128 v[92:95], v17 offset:6144
    ds_read_b64_tr_b16 v[96:97], v18 offset:4096
    v_mfma_f32_16x16x32_bf16 v[204:207], v[112:115], v[76:79], v[204:207]
    ds_read_b64_tr_b16 v[98:99], v18 offset:4608
    v_mfma_f32_16x16x32_bf16 v[208:211], v[116:119], v[64:67], v[208:211]
    ds_read_b64_tr_b16 v[100:101], v19 offset:4096
    ds_read_b64_tr_b16 v[102:103], v19 offset:4608
    v_mfma_f32_16x16x32_bf16 v[212:215], v[116:119], v[68:71], v[212:215]
    ds_read_b64_tr_b16 v[104:105], v20 offset:4096
    v_mfma_f32_16x16x32_bf16 v[216:219], v[116:119], v[72:75], v[216:219]
    ds_read_b64_tr_b16 v[106:107], v20 offset:4608
    ds_read_b64_tr_b16 v[108:109], v21 offset:4096
    v_mfma_f32_16x16x32_bf16 v[220:223], v[116:119], v[76:79], v[220:223]
    ds_read_b64_tr_b16 v[110:111], v21 offset:4608
    v_mfma_f32_16x16x32_bf16 v[224:227], v[120:123], v[64:67], v[224:227]
    v_mfma_f32_16x16x32_bf16 v[228:231], v[120:123], v[68:71], v[228:231]
    v_mfma_f32_16x16x32_bf16 v[232:235], v[120:123], v[72:75], v[232:235]
    v_mfma_f32_16x16x32_bf16 v[236:239], v[120:123], v[76:79], v[236:239]
    v_mfma_f32_16x16x32_bf16 v[240:243], v[124:127], v[64:67], v[240:243]
    v_mfma_f32_16x16x32_bf16 v[244:247], v[124:127], v[68:71], v[244:247]
    v_mfma_f32_16x16x32_bf16 v[248:251], v[124:127], v[72:75], v[248:251]
    v_mfma_f32_16x16x32_bf16 v[252:255], v[124:127], v[76:79], v[252:255]
    s_waitcnt lgkmcnt(0)
    v_mfma_f32_16x16x32_bf16 v[128:131], v[96:99], v[80:83], v[128:131]
    ds_read_b64_tr_b16 v[112:113], v18 offset:20480
    v_mfma_f32_16x16x32_bf16 v[132:135], v[96:99], v[84:87], v[132:135]
    ds_read_b64_tr_b16 v[114:115], v18 offset:20992
    v_mfma_f32_16x16x32_bf16 v[136:139], v[96:99], v[88:91], v[136:139]
    ds_read_b64_tr_b16 v[116:117], v19 offset:20480
    v_mfma_f32_16x16x32_bf16 v[140:143], v[96:99], v[92:95], v[140:143]
    ds_read_b64_tr_b16 v[118:119], v19 offset:20992
    v_mfma_f32_16x16x32_bf16 v[144:147], v[100:103], v[80:83], v[144:147]
    ds_read_b64_tr_b16 v[120:121], v20 offset:20480
    v_mfma_f32_16x16x32_bf16 v[148:151], v[100:103], v[84:87], v[148:151]
    ds_read_b64_tr_b16 v[122:123], v20 offset:20992
    v_mfma_f32_16x16x32_bf16 v[152:155], v[100:103], v[88:91], v[152:155]
    ds_read_b64_tr_b16 v[124:125], v21 offset:20480
    v_mfma_f32_16x16x32_bf16 v[156:159], v[100:103], v[92:95], v[156:159]
    ds_read_b64_tr_b16 v[126:127], v21 offset:20992
    v_mfma_f32_16x16x32_bf16 v[160:163], v[104:107], v[80:83], v[160:163]
    v_mfma_f32_16x16x32_bf16 v[164:167], v[104:107], v[84:87], v[164:167]
    v_mfma_f32_16x16x32_bf16 v[168:171], v[104:107], v[88:91], v[168:171]
    v_mfma_f32_16x16x32_bf16 v[172:175], v[104:107], v[92:95], v[172:175]
    v_mfma_f32_16x16x32_bf16 v[176:179], v[108:111], v[80:83], v[176:179]
    v_mfma_f32_16x16x32_bf16 v[180:183], v[108:111], v[84:87], v[180:183]
    v_mfma_f32_16x16x32_bf16 v[184:187], v[108:111], v[88:91], v[184:187]
    v_mfma_f32_16x16x32_bf16 v[188:191], v[108:111], v[92:95], v[188:191]
    s_waitcnt lgkmcnt(0)
    s_waitcnt vmcnt(0)
    s_barrier
    v_mfma_f32_16x16x32_bf16 v[192:195], v[112:115], v[80:83], v[192:195]
    ds_read_b128 v[64:67], v22 offset:0
    ds_read_b128 v[68:71], v22 offset:2048
    v_mfma_f32_16x16x32_bf16 v[196:199], v[112:115], v[84:87], v[196:199]
    ds_read_b128 v[72:75], v22 offset:4096
    v_mfma_f32_16x16x32_bf16 v[200:203], v[112:115], v[88:91], v[200:203]
    ds_read_b128 v[76:79], v22 offset:6144
    ds_read_b64_tr_b16 v[96:97], v24 offset:0
    v_mfma_f32_16x16x32_bf16 v[204:207], v[112:115], v[92:95], v[204:207]
    ds_read_b64_tr_b16 v[98:99], v24 offset:512
    v_mfma_f32_16x16x32_bf16 v[208:211], v[116:119], v[80:83], v[208:211]
    ds_read_b64_tr_b16 v[100:101], v25 offset:0
    ds_read_b64_tr_b16 v[102:103], v25 offset:512
    v_mfma_f32_16x16x32_bf16 v[212:215], v[116:119], v[84:87], v[212:215]
    ds_read_b64_tr_b16 v[104:105], v26 offset:0
    v_mfma_f32_16x16x32_bf16 v[216:219], v[116:119], v[88:91], v[216:219]
    ds_read_b64_tr_b16 v[106:107], v26 offset:512
    ds_read_b64_tr_b16 v[108:109], v27 offset:0
    v_mfma_f32_16x16x32_bf16 v[220:223], v[116:119], v[92:95], v[220:223]
    ds_read_b64_tr_b16 v[110:111], v27 offset:512
    v_mfma_f32_16x16x32_bf16 v[224:227], v[120:123], v[80:83], v[224:227]
    v_mfma_f32_16x16x32_bf16 v[228:231], v[120:123], v[84:87], v[228:231]
    v_mfma_f32_16x16x32_bf16 v[232:235], v[120:123], v[88:91], v[232:235]
    v_mfma_f32_16x16x32_bf16 v[236:239], v[120:123], v[92:95], v[236:239]
    v_mfma_f32_16x16x32_bf16 v[240:243], v[124:127], v[80:83], v[240:243]
    v_mfma_f32_16x16x32_bf16 v[244:247], v[124:127], v[84:87], v[244:247]
    v_mfma_f32_16x16x32_bf16 v[248:251], v[124:127], v[88:91], v[248:251]
    v_mfma_f32_16x16x32_bf16 v[252:255], v[124:127], v[92:95], v[252:255]
    s_waitcnt lgkmcnt(0)
    v_mfma_f32_16x16x32_bf16 v[128:131], v[96:99], v[64:67], v[128:131]
    ds_read_b64_tr_b16 v[112:113], v24 offset:16384
    v_mfma_f32_16x16x32_bf16 v[132:135], v[96:99], v[68:71], v[132:135]
    ds_read_b64_tr_b16 v[114:115], v24 offset:16896
    v_mfma_f32_16x16x32_bf16 v[136:139], v[96:99], v[72:75], v[136:139]
    ds_read_b64_tr_b16 v[116:117], v25 offset:16384
    v_mfma_f32_16x16x32_bf16 v[140:143], v[96:99], v[76:79], v[140:143]
    ds_read_b64_tr_b16 v[118:119], v25 offset:16896
    v_mfma_f32_16x16x32_bf16 v[144:147], v[100:103], v[64:67], v[144:147]
    ds_read_b64_tr_b16 v[120:121], v26 offset:16384
    v_mfma_f32_16x16x32_bf16 v[148:151], v[100:103], v[68:71], v[148:151]
    ds_read_b64_tr_b16 v[122:123], v26 offset:16896
    v_mfma_f32_16x16x32_bf16 v[152:155], v[100:103], v[72:75], v[152:155]
    ds_read_b64_tr_b16 v[124:125], v27 offset:16384
    v_mfma_f32_16x16x32_bf16 v[156:159], v[100:103], v[76:79], v[156:159]
    ds_read_b64_tr_b16 v[126:127], v27 offset:16896
    v_mfma_f32_16x16x32_bf16 v[160:163], v[104:107], v[64:67], v[160:163]
    v_mfma_f32_16x16x32_bf16 v[164:167], v[104:107], v[68:71], v[164:167]
    v_mfma_f32_16x16x32_bf16 v[168:171], v[104:107], v[72:75], v[168:171]
    v_mfma_f32_16x16x32_bf16 v[172:175], v[104:107], v[76:79], v[172:175]
    v_mfma_f32_16x16x32_bf16 v[176:179], v[108:111], v[64:67], v[176:179]
    v_mfma_f32_16x16x32_bf16 v[180:183], v[108:111], v[68:71], v[180:183]
    v_mfma_f32_16x16x32_bf16 v[184:187], v[108:111], v[72:75], v[184:187]
    v_mfma_f32_16x16x32_bf16 v[188:191], v[108:111], v[76:79], v[188:191]
    s_waitcnt lgkmcnt(0)
    v_mfma_f32_16x16x32_bf16 v[192:195], v[112:115], v[64:67], v[192:195]
    ds_read_b128 v[80:83], v23 offset:0
    ds_read_b128 v[84:87], v23 offset:2048
    v_mfma_f32_16x16x32_bf16 v[196:199], v[112:115], v[68:71], v[196:199]
    ds_read_b128 v[88:91], v23 offset:4096
    v_mfma_f32_16x16x32_bf16 v[200:203], v[112:115], v[72:75], v[200:203]
    ds_read_b128 v[92:95], v23 offset:6144
    ds_read_b64_tr_b16 v[96:97], v24 offset:4096
    v_mfma_f32_16x16x32_bf16 v[204:207], v[112:115], v[76:79], v[204:207]
    ds_read_b64_tr_b16 v[98:99], v24 offset:4608
    v_mfma_f32_16x16x32_bf16 v[208:211], v[116:119], v[64:67], v[208:211]
    ds_read_b64_tr_b16 v[100:101], v25 offset:4096
    ds_read_b64_tr_b16 v[102:103], v25 offset:4608
    v_mfma_f32_16x16x32_bf16 v[212:215], v[116:119], v[68:71], v[212:215]
    ds_read_b64_tr_b16 v[104:105], v26 offset:4096
    v_mfma_f32_16x16x32_bf16 v[216:219], v[116:119], v[72:75], v[216:219]
    ds_read_b64_tr_b16 v[106:107], v26 offset:4608
    ds_read_b64_tr_b16 v[108:109], v27 offset:4096
    v_mfma_f32_16x16x32_bf16 v[220:223], v[116:119], v[76:79], v[220:223]
    ds_read_b64_tr_b16 v[110:111], v27 offset:4608
    v_mfma_f32_16x16x32_bf16 v[224:227], v[120:123], v[64:67], v[224:227]
    v_mfma_f32_16x16x32_bf16 v[228:231], v[120:123], v[68:71], v[228:231]
    v_mfma_f32_16x16x32_bf16 v[232:235], v[120:123], v[72:75], v[232:235]
    v_mfma_f32_16x16x32_bf16 v[236:239], v[120:123], v[76:79], v[236:239]
    v_mfma_f32_16x16x32_bf16 v[240:243], v[124:127], v[64:67], v[240:243]
    v_mfma_f32_16x16x32_bf16 v[244:247], v[124:127], v[68:71], v[244:247]
    v_mfma_f32_16x16x32_bf16 v[248:251], v[124:127], v[72:75], v[248:251]
    v_mfma_f32_16x16x32_bf16 v[252:255], v[124:127], v[76:79], v[252:255]
    s_waitcnt lgkmcnt(0)
    v_mfma_f32_16x16x32_bf16 v[128:131], v[96:99], v[80:83], v[128:131]
    ds_read_b64_tr_b16 v[112:113], v24 offset:20480
    v_mfma_f32_16x16x32_bf16 v[132:135], v[96:99], v[84:87], v[132:135]
    ds_read_b64_tr_b16 v[114:115], v24 offset:20992
    v_mfma_f32_16x16x32_bf16 v[136:139], v[96:99], v[88:91], v[136:139]
    ds_read_b64_tr_b16 v[116:117], v25 offset:20480
    v_mfma_f32_16x16x32_bf16 v[140:143], v[96:99], v[92:95], v[140:143]
    ds_read_b64_tr_b16 v[118:119], v25 offset:20992
    v_mfma_f32_16x16x32_bf16 v[144:147], v[100:103], v[80:83], v[144:147]
    ds_read_b64_tr_b16 v[120:121], v26 offset:20480
    v_mfma_f32_16x16x32_bf16 v[148:151], v[100:103], v[84:87], v[148:151]
    ds_read_b64_tr_b16 v[122:123], v26 offset:20992
    v_mfma_f32_16x16x32_bf16 v[152:155], v[100:103], v[88:91], v[152:155]
    ds_read_b64_tr_b16 v[124:125], v27 offset:20480
    v_mfma_f32_16x16x32_bf16 v[156:159], v[100:103], v[92:95], v[156:159]
    ds_read_b64_tr_b16 v[126:127], v27 offset:20992
    v_mfma_f32_16x16x32_bf16 v[160:163], v[104:107], v[80:83], v[160:163]
    v_mfma_f32_16x16x32_bf16 v[164:167], v[104:107], v[84:87], v[164:167]
    v_mfma_f32_16x16x32_bf16 v[168:171], v[104:107], v[88:91], v[168:171]
    v_mfma_f32_16x16x32_bf16 v[172:175], v[104:107], v[92:95], v[172:175]
    v_mfma_f32_16x16x32_bf16 v[176:179], v[108:111], v[80:83], v[176:179]
    v_mfma_f32_16x16x32_bf16 v[180:183], v[108:111], v[84:87], v[180:183]
    v_mfma_f32_16x16x32_bf16 v[184:187], v[108:111], v[88:91], v[184:187]
    v_mfma_f32_16x16x32_bf16 v[188:191], v[108:111], v[92:95], v[188:191]
    s_waitcnt lgkmcnt(0)
    v_mfma_f32_16x16x32_bf16 v[192:195], v[112:115], v[80:83], v[192:195]
    v_mfma_f32_16x16x32_bf16 v[196:199], v[112:115], v[84:87], v[196:199]
    v_mfma_f32_16x16x32_bf16 v[200:203], v[112:115], v[88:91], v[200:203]
    v_mfma_f32_16x16x32_bf16 v[204:207], v[112:115], v[92:95], v[204:207]
    v_mfma_f32_16x16x32_bf16 v[208:211], v[116:119], v[80:83], v[208:211]
    v_mfma_f32_16x16x32_bf16 v[212:215], v[116:119], v[84:87], v[212:215]
    v_mfma_f32_16x16x32_bf16 v[216:219], v[116:119], v[88:91], v[216:219]
    v_mfma_f32_16x16x32_bf16 v[220:223], v[116:119], v[92:95], v[220:223]
    v_mfma_f32_16x16x32_bf16 v[224:227], v[120:123], v[80:83], v[224:227]
    v_mfma_f32_16x16x32_bf16 v[228:231], v[120:123], v[84:87], v[228:231]
    v_mfma_f32_16x16x32_bf16 v[232:235], v[120:123], v[88:91], v[232:235]
    v_mfma_f32_16x16x32_bf16 v[236:239], v[120:123], v[92:95], v[236:239]
    v_mfma_f32_16x16x32_bf16 v[240:243], v[124:127], v[80:83], v[240:243]
    v_mfma_f32_16x16x32_bf16 v[244:247], v[124:127], v[84:87], v[244:247]
    v_mfma_f32_16x16x32_bf16 v[248:251], v[124:127], v[88:91], v[248:251]
    v_mfma_f32_16x16x32_bf16 v[252:255], v[124:127], v[92:95], v[252:255]
    s_nop 7
    s_nop 7
    v_lshrrev_b32 v41, 1, v2
    v_mul_u32_u24 v40, 0x38000, v41
    v_and_b32 v41, 1, v2
    v_lshl_add_u32 v40, v41, 11, v40
    v_lshl_add_u32 v40, v1, 4, v40
    s_mul_i32 s52, s46, 0x70000
    s_lshl_b32 s53, s47, 12
    s_add_u32 s52, s52, s53
    s_mov_b32 s60, 0xbfb8aa3b
    s_mov_b32 s61, 0xbfb8aa3b
    s_mov_b32 s62, 1.0
    s_mov_b32 s63, 1.0
    v_cvt_pk_bf16_f32 v44, v128, v129
    v_cvt_pk_bf16_f32 v46, v130, v131
    v_cvt_pk_bf16_f32 v48, v144, v145
    v_cvt_pk_bf16_f32 v50, v146, v147
    v_lshlrev_b32 v128, 16, v44
    v_and_b32 v129, 0xffff0000, v44
    v_lshlrev_b32 v130, 16, v46
    v_and_b32 v131, 0xffff0000, v46
    v_lshlrev_b32 v144, 16, v48
    v_and_b32 v145, 0xffff0000, v48
    v_lshlrev_b32 v146, 16, v50
    v_and_b32 v147, 0xffff0000, v50
    v_pk_mul_f32 v[44:45], v[128:129], s[60:61]
    v_pk_mul_f32 v[46:47], v[130:131], s[60:61]
    v_pk_mul_f32 v[48:49], v[144:145], s[60:61]
    v_pk_mul_f32 v[50:51], v[146:147], s[60:61]
    v_exp_f32 v44, v44
    v_exp_f32 v45, v45
    v_exp_f32 v46, v46
    v_exp_f32 v47, v47
    v_exp_f32 v48, v48
    v_exp_f32 v49, v49
    v_exp_f32 v50, v50
    v_exp_f32 v51, v51
    v_pk_add_f32 v[44:45], v[44:45], s[62:63]
    v_pk_add_f32 v[46:47], v[46:47], s[62:63]
    v_pk_add_f32 v[48:49], v[48:49], s[62:63]
    v_pk_add_f32 v[50:51], v[50:51], s[62:63]
    v_rcp_f32 v44, v44
    v_rcp_f32 v45, v45
    v_rcp_f32 v46, v46
    v_rcp_f32 v47, v47
    v_rcp_f32 v48, v48
    v_rcp_f32 v49, v49
    v_rcp_f32 v50, v50
    v_rcp_f32 v51, v51
    v_pk_mul_f32 v[128:129], v[128:129], v[44:45]
    v_pk_mul_f32 v[130:131], v[130:131], v[46:47]
    v_pk_mul_f32 v[144:145], v[144:145], v[48:49]
    v_pk_mul_f32 v[146:147], v[146:147], v[50:51]
    v_cvt_pk_bf16_f32 v44, v128, v129
    v_cvt_pk_bf16_f32 v45, v192, v193
    v_cvt_pk_bf16_f32 v46, v130, v131
    v_cvt_pk_bf16_f32 v47, v194, v195
    v_cvt_pk_bf16_f32 v48, v144, v145
    v_cvt_pk_bf16_f32 v49, v208, v209
    v_cvt_pk_bf16_f32 v50, v146, v147
    v_cvt_pk_bf16_f32 v51, v210, v211
    v_lshlrev_b32 v128, 16, v44
    v_and_b32 v129, 0xffff0000, v44
    v_lshlrev_b32 v130, 16, v46
    v_and_b32 v131, 0xffff0000, v46
    v_lshlrev_b32 v144, 16, v48
    v_and_b32 v145, 0xffff0000, v48
    v_lshlrev_b32 v146, 16, v50
    v_and_b32 v147, 0xffff0000, v50
    v_lshlrev_b32 v192, 16, v45
    v_and_b32 v193, 0xffff0000, v45
    v_lshlrev_b32 v194, 16, v47
    v_and_b32 v195, 0xffff0000, v47
    v_lshlrev_b32 v208, 16, v49
    v_and_b32 v209, 0xffff0000, v49
    v_lshlrev_b32 v210, 16, v51
    v_and_b32 v211, 0xffff0000, v51
    v_pk_mul_f32 v[128:129], v[128:129], v[192:193]
    v_pk_mul_f32 v[130:131], v[130:131], v[194:195]
    v_pk_mul_f32 v[144:145], v[144:145], v[208:209]
    v_pk_mul_f32 v[146:147], v[146:147], v[210:211]
    v_cvt_pk_bf16_f32 v128, v128, v129
    v_cvt_pk_bf16_f32 v129, v130, v131
    v_cvt_pk_bf16_f32 v130, v144, v145
    v_cvt_pk_bf16_f32 v131, v146, v147
    s_add_u32 s53, s52, 0x0
    buffer_store_dwordx4 v[128:131], v40, s[24:27], s53 offen
    v_cvt_pk_bf16_f32 v44, v160, v161
    v_cvt_pk_bf16_f32 v46, v162, v163
    v_cvt_pk_bf16_f32 v48, v176, v177
    v_cvt_pk_bf16_f32 v50, v178, v179
    v_lshlrev_b32 v160, 16, v44
    v_and_b32 v161, 0xffff0000, v44
    v_lshlrev_b32 v162, 16, v46
    v_and_b32 v163, 0xffff0000, v46
    v_lshlrev_b32 v176, 16, v48
    v_and_b32 v177, 0xffff0000, v48
    v_lshlrev_b32 v178, 16, v50
    v_and_b32 v179, 0xffff0000, v50
    v_pk_mul_f32 v[44:45], v[160:161], s[60:61]
    v_pk_mul_f32 v[46:47], v[162:163], s[60:61]
    v_pk_mul_f32 v[48:49], v[176:177], s[60:61]
    v_pk_mul_f32 v[50:51], v[178:179], s[60:61]
    v_exp_f32 v44, v44
    v_exp_f32 v45, v45
    v_exp_f32 v46, v46
    v_exp_f32 v47, v47
    v_exp_f32 v48, v48
    v_exp_f32 v49, v49
    v_exp_f32 v50, v50
    v_exp_f32 v51, v51
    v_pk_add_f32 v[44:45], v[44:45], s[62:63]
    v_pk_add_f32 v[46:47], v[46:47], s[62:63]
    v_pk_add_f32 v[48:49], v[48:49], s[62:63]
    v_pk_add_f32 v[50:51], v[50:51], s[62:63]
    v_rcp_f32 v44, v44
    v_rcp_f32 v45, v45
    v_rcp_f32 v46, v46
    v_rcp_f32 v47, v47
    v_rcp_f32 v48, v48
    v_rcp_f32 v49, v49
    v_rcp_f32 v50, v50
    v_rcp_f32 v51, v51
    v_pk_mul_f32 v[160:161], v[160:161], v[44:45]
    v_pk_mul_f32 v[162:163], v[162:163], v[46:47]
    v_pk_mul_f32 v[176:177], v[176:177], v[48:49]
    v_pk_mul_f32 v[178:179], v[178:179], v[50:51]
    v_cvt_pk_bf16_f32 v44, v160, v161
    v_cvt_pk_bf16_f32 v45, v224, v225
    v_cvt_pk_bf16_f32 v46, v162, v163
    v_cvt_pk_bf16_f32 v47, v226, v227
    v_cvt_pk_bf16_f32 v48, v176, v177
    v_cvt_pk_bf16_f32 v49, v240, v241
    v_cvt_pk_bf16_f32 v50, v178, v179
    v_cvt_pk_bf16_f32 v51, v242, v243
    v_lshlrev_b32 v160, 16, v44
    v_and_b32 v161, 0xffff0000, v44
    v_lshlrev_b32 v162, 16, v46
    v_and_b32 v163, 0xffff0000, v46
    v_lshlrev_b32 v176, 16, v48
    v_and_b32 v177, 0xffff0000, v48
    v_lshlrev_b32 v178, 16, v50
    v_and_b32 v179, 0xffff0000, v50
    v_lshlrev_b32 v224, 16, v45
    v_and_b32 v225, 0xffff0000, v45
    v_lshlrev_b32 v226, 16, v47
    v_and_b32 v227, 0xffff0000, v47
    v_lshlrev_b32 v240, 16, v49
    v_and_b32 v241, 0xffff0000, v49
    v_lshlrev_b32 v242, 16, v51
    v_and_b32 v243, 0xffff0000, v51
    v_pk_mul_f32 v[160:161], v[160:161], v[224:225]
    v_pk_mul_f32 v[162:163], v[162:163], v[226:227]
    v_pk_mul_f32 v[176:177], v[176:177], v[240:241]
    v_pk_mul_f32 v[178:179], v[178:179], v[242:243]
    v_cvt_pk_bf16_f32 v160, v160, v161
    v_cvt_pk_bf16_f32 v161, v162, v163
    v_cvt_pk_bf16_f32 v162, v176, v177
    v_cvt_pk_bf16_f32 v163, v178, v179
    s_add_u32 s53, s52, 0x400
    buffer_store_dwordx4 v[160:163], v40, s[24:27], s53 offen
    v_cvt_pk_bf16_f32 v44, v132, v133
    v_cvt_pk_bf16_f32 v46, v134, v135
    v_cvt_pk_bf16_f32 v48, v148, v149
    v_cvt_pk_bf16_f32 v50, v150, v151
    v_lshlrev_b32 v132, 16, v44
    v_and_b32 v133, 0xffff0000, v44
    v_lshlrev_b32 v134, 16, v46
    v_and_b32 v135, 0xffff0000, v46
    v_lshlrev_b32 v148, 16, v48
    v_and_b32 v149, 0xffff0000, v48
    v_lshlrev_b32 v150, 16, v50
    v_and_b32 v151, 0xffff0000, v50
    v_pk_mul_f32 v[44:45], v[132:133], s[60:61]
    v_pk_mul_f32 v[46:47], v[134:135], s[60:61]
    v_pk_mul_f32 v[48:49], v[148:149], s[60:61]
    v_pk_mul_f32 v[50:51], v[150:151], s[60:61]
    v_exp_f32 v44, v44
    v_exp_f32 v45, v45
    v_exp_f32 v46, v46
    v_exp_f32 v47, v47
    v_exp_f32 v48, v48
    v_exp_f32 v49, v49
    v_exp_f32 v50, v50
    v_exp_f32 v51, v51
    v_pk_add_f32 v[44:45], v[44:45], s[62:63]
    v_pk_add_f32 v[46:47], v[46:47], s[62:63]
    v_pk_add_f32 v[48:49], v[48:49], s[62:63]
    v_pk_add_f32 v[50:51], v[50:51], s[62:63]
    v_rcp_f32 v44, v44
    v_rcp_f32 v45, v45
    v_rcp_f32 v46, v46
    v_rcp_f32 v47, v47
    v_rcp_f32 v48, v48
    v_rcp_f32 v49, v49
    v_rcp_f32 v50, v50
    v_rcp_f32 v51, v51
    v_pk_mul_f32 v[132:133], v[132:133], v[44:45]
    v_pk_mul_f32 v[134:135], v[134:135], v[46:47]
    v_pk_mul_f32 v[148:149], v[148:149], v[48:49]
    v_pk_mul_f32 v[150:151], v[150:151], v[50:51]
    v_cvt_pk_bf16_f32 v44, v132, v133
    v_cvt_pk_bf16_f32 v45, v196, v197
    v_cvt_pk_bf16_f32 v46, v134, v135
    v_cvt_pk_bf16_f32 v47, v198, v199
    v_cvt_pk_bf16_f32 v48, v148, v149
    v_cvt_pk_bf16_f32 v49, v212, v213
    v_cvt_pk_bf16_f32 v50, v150, v151
    v_cvt_pk_bf16_f32 v51, v214, v215
    v_lshlrev_b32 v132, 16, v44
    v_and_b32 v133, 0xffff0000, v44
    v_lshlrev_b32 v134, 16, v46
    v_and_b32 v135, 0xffff0000, v46
    v_lshlrev_b32 v148, 16, v48
    v_and_b32 v149, 0xffff0000, v48
    v_lshlrev_b32 v150, 16, v50
    v_and_b32 v151, 0xffff0000, v50
    v_lshlrev_b32 v196, 16, v45
    v_and_b32 v197, 0xffff0000, v45
    v_lshlrev_b32 v198, 16, v47
    v_and_b32 v199, 0xffff0000, v47
    v_lshlrev_b32 v212, 16, v49
    v_and_b32 v213, 0xffff0000, v49
    v_lshlrev_b32 v214, 16, v51
    v_and_b32 v215, 0xffff0000, v51
    v_pk_mul_f32 v[132:133], v[132:133], v[196:197]
    v_pk_mul_f32 v[134:135], v[134:135], v[198:199]
    v_pk_mul_f32 v[148:149], v[148:149], v[212:213]
    v_pk_mul_f32 v[150:151], v[150:151], v[214:215]
    v_cvt_pk_bf16_f32 v132, v132, v133
    v_cvt_pk_bf16_f32 v133, v134, v135
    v_cvt_pk_bf16_f32 v134, v148, v149
    v_cvt_pk_bf16_f32 v135, v150, v151
    s_add_u32 s53, s52, 0xe000
    buffer_store_dwordx4 v[132:135], v40, s[24:27], s53 offen
    v_cvt_pk_bf16_f32 v44, v164, v165
    v_cvt_pk_bf16_f32 v46, v166, v167
    v_cvt_pk_bf16_f32 v48, v180, v181
    v_cvt_pk_bf16_f32 v50, v182, v183
    v_lshlrev_b32 v164, 16, v44
    v_and_b32 v165, 0xffff0000, v44
    v_lshlrev_b32 v166, 16, v46
    v_and_b32 v167, 0xffff0000, v46
    v_lshlrev_b32 v180, 16, v48
    v_and_b32 v181, 0xffff0000, v48
    v_lshlrev_b32 v182, 16, v50
    v_and_b32 v183, 0xffff0000, v50
    v_pk_mul_f32 v[44:45], v[164:165], s[60:61]
    v_pk_mul_f32 v[46:47], v[166:167], s[60:61]
    v_pk_mul_f32 v[48:49], v[180:181], s[60:61]
    v_pk_mul_f32 v[50:51], v[182:183], s[60:61]
    v_exp_f32 v44, v44
    v_exp_f32 v45, v45
    v_exp_f32 v46, v46
    v_exp_f32 v47, v47
    v_exp_f32 v48, v48
    v_exp_f32 v49, v49
    v_exp_f32 v50, v50
    v_exp_f32 v51, v51
    v_pk_add_f32 v[44:45], v[44:45], s[62:63]
    v_pk_add_f32 v[46:47], v[46:47], s[62:63]
    v_pk_add_f32 v[48:49], v[48:49], s[62:63]
    v_pk_add_f32 v[50:51], v[50:51], s[62:63]
    v_rcp_f32 v44, v44
    v_rcp_f32 v45, v45
    v_rcp_f32 v46, v46
    v_rcp_f32 v47, v47
    v_rcp_f32 v48, v48
    v_rcp_f32 v49, v49
    v_rcp_f32 v50, v50
    v_rcp_f32 v51, v51
    v_pk_mul_f32 v[164:165], v[164:165], v[44:45]
    v_pk_mul_f32 v[166:167], v[166:167], v[46:47]
    v_pk_mul_f32 v[180:181], v[180:181], v[48:49]
    v_pk_mul_f32 v[182:183], v[182:183], v[50:51]
    v_cvt_pk_bf16_f32 v44, v164, v165
    v_cvt_pk_bf16_f32 v45, v228, v229
    v_cvt_pk_bf16_f32 v46, v166, v167
    v_cvt_pk_bf16_f32 v47, v230, v231
    v_cvt_pk_bf16_f32 v48, v180, v181
    v_cvt_pk_bf16_f32 v49, v244, v245
    v_cvt_pk_bf16_f32 v50, v182, v183
    v_cvt_pk_bf16_f32 v51, v246, v247
    v_lshlrev_b32 v164, 16, v44
    v_and_b32 v165, 0xffff0000, v44
    v_lshlrev_b32 v166, 16, v46
    v_and_b32 v167, 0xffff0000, v46
    v_lshlrev_b32 v180, 16, v48
    v_and_b32 v181, 0xffff0000, v48
    v_lshlrev_b32 v182, 16, v50
    v_and_b32 v183, 0xffff0000, v50
    v_lshlrev_b32 v228, 16, v45
    v_and_b32 v229, 0xffff0000, v45
    v_lshlrev_b32 v230, 16, v47
    v_and_b32 v231, 0xffff0000, v47
    v_lshlrev_b32 v244, 16, v49
    v_and_b32 v245, 0xffff0000, v49
    v_lshlrev_b32 v246, 16, v51
    v_and_b32 v247, 0xffff0000, v51
    v_pk_mul_f32 v[164:165], v[164:165], v[228:229]
    v_pk_mul_f32 v[166:167], v[166:167], v[230:231]
    v_pk_mul_f32 v[180:181], v[180:181], v[244:245]
    v_pk_mul_f32 v[182:183], v[182:183], v[246:247]
    v_cvt_pk_bf16_f32 v164, v164, v165
    v_cvt_pk_bf16_f32 v165, v166, v167
    v_cvt_pk_bf16_f32 v166, v180, v181
    v_cvt_pk_bf16_f32 v167, v182, v183
    s_add_u32 s53, s52, 0xe400
    buffer_store_dwordx4 v[164:167], v40, s[24:27], s53 offen
    v_cvt_pk_bf16_f32 v44, v136, v137
    v_cvt_pk_bf16_f32 v46, v138, v139
    v_cvt_pk_bf16_f32 v48, v152, v153
    v_cvt_pk_bf16_f32 v50, v154, v155
    v_lshlrev_b32 v136, 16, v44
    v_and_b32 v137, 0xffff0000, v44
    v_lshlrev_b32 v138, 16, v46
    v_and_b32 v139, 0xffff0000, v46
    v_lshlrev_b32 v152, 16, v48
    v_and_b32 v153, 0xffff0000, v48
    v_lshlrev_b32 v154, 16, v50
    v_and_b32 v155, 0xffff0000, v50
    v_pk_mul_f32 v[44:45], v[136:137], s[60:61]
    v_pk_mul_f32 v[46:47], v[138:139], s[60:61]
    v_pk_mul_f32 v[48:49], v[152:153], s[60:61]
    v_pk_mul_f32 v[50:51], v[154:155], s[60:61]
    v_exp_f32 v44, v44
    v_exp_f32 v45, v45
    v_exp_f32 v46, v46
    v_exp_f32 v47, v47
    v_exp_f32 v48, v48
    v_exp_f32 v49, v49
    v_exp_f32 v50, v50
    v_exp_f32 v51, v51
    v_pk_add_f32 v[44:45], v[44:45], s[62:63]
    v_pk_add_f32 v[46:47], v[46:47], s[62:63]
    v_pk_add_f32 v[48:49], v[48:49], s[62:63]
    v_pk_add_f32 v[50:51], v[50:51], s[62:63]
    v_rcp_f32 v44, v44
    v_rcp_f32 v45, v45
    v_rcp_f32 v46, v46
    v_rcp_f32 v47, v47
    v_rcp_f32 v48, v48
    v_rcp_f32 v49, v49
    v_rcp_f32 v50, v50
    v_rcp_f32 v51, v51
    v_pk_mul_f32 v[136:137], v[136:137], v[44:45]
    v_pk_mul_f32 v[138:139], v[138:139], v[46:47]
    v_pk_mul_f32 v[152:153], v[152:153], v[48:49]
    v_pk_mul_f32 v[154:155], v[154:155], v[50:51]
    v_cvt_pk_bf16_f32 v44, v136, v137
    v_cvt_pk_bf16_f32 v45, v200, v201
    v_cvt_pk_bf16_f32 v46, v138, v139
    v_cvt_pk_bf16_f32 v47, v202, v203
    v_cvt_pk_bf16_f32 v48, v152, v153
    v_cvt_pk_bf16_f32 v49, v216, v217
    v_cvt_pk_bf16_f32 v50, v154, v155
    v_cvt_pk_bf16_f32 v51, v218, v219
    v_lshlrev_b32 v136, 16, v44
    v_and_b32 v137, 0xffff0000, v44
    v_lshlrev_b32 v138, 16, v46
    v_and_b32 v139, 0xffff0000, v46
    v_lshlrev_b32 v152, 16, v48
    v_and_b32 v153, 0xffff0000, v48
    v_lshlrev_b32 v154, 16, v50
    v_and_b32 v155, 0xffff0000, v50
    v_lshlrev_b32 v200, 16, v45
    v_and_b32 v201, 0xffff0000, v45
    v_lshlrev_b32 v202, 16, v47
    v_and_b32 v203, 0xffff0000, v47
    v_lshlrev_b32 v216, 16, v49
    v_and_b32 v217, 0xffff0000, v49
    v_lshlrev_b32 v218, 16, v51
    v_and_b32 v219, 0xffff0000, v51
    v_pk_mul_f32 v[136:137], v[136:137], v[200:201]
    v_pk_mul_f32 v[138:139], v[138:139], v[202:203]
    v_pk_mul_f32 v[152:153], v[152:153], v[216:217]
    v_pk_mul_f32 v[154:155], v[154:155], v[218:219]
    v_cvt_pk_bf16_f32 v136, v136, v137
    v_cvt_pk_bf16_f32 v137, v138, v139
    v_cvt_pk_bf16_f32 v138, v152, v153
    v_cvt_pk_bf16_f32 v139, v154, v155
    s_add_u32 s53, s52, 0x1c000
    buffer_store_dwordx4 v[136:139], v40, s[24:27], s53 offen
    v_cvt_pk_bf16_f32 v44, v168, v169
    v_cvt_pk_bf16_f32 v46, v170, v171
    v_cvt_pk_bf16_f32 v48, v184, v185
    v_cvt_pk_bf16_f32 v50, v186, v187
    v_lshlrev_b32 v168, 16, v44
    v_and_b32 v169, 0xffff0000, v44
    v_lshlrev_b32 v170, 16, v46
    v_and_b32 v171, 0xffff0000, v46
    v_lshlrev_b32 v184, 16, v48
    v_and_b32 v185, 0xffff0000, v48
    v_lshlrev_b32 v186, 16, v50
    v_and_b32 v187, 0xffff0000, v50
    v_pk_mul_f32 v[44:45], v[168:169], s[60:61]
    v_pk_mul_f32 v[46:47], v[170:171], s[60:61]
    v_pk_mul_f32 v[48:49], v[184:185], s[60:61]
    v_pk_mul_f32 v[50:51], v[186:187], s[60:61]
    v_exp_f32 v44, v44
    v_exp_f32 v45, v45
    v_exp_f32 v46, v46
    v_exp_f32 v47, v47
    v_exp_f32 v48, v48
    v_exp_f32 v49, v49
    v_exp_f32 v50, v50
    v_exp_f32 v51, v51
    v_pk_add_f32 v[44:45], v[44:45], s[62:63]
    v_pk_add_f32 v[46:47], v[46:47], s[62:63]
    v_pk_add_f32 v[48:49], v[48:49], s[62:63]
    v_pk_add_f32 v[50:51], v[50:51], s[62:63]
    v_rcp_f32 v44, v44
    v_rcp_f32 v45, v45
    v_rcp_f32 v46, v46
    v_rcp_f32 v47, v47
    v_rcp_f32 v48, v48
    v_rcp_f32 v49, v49
    v_rcp_f32 v50, v50
    v_rcp_f32 v51, v51
    v_pk_mul_f32 v[168:169], v[168:169], v[44:45]
    v_pk_mul_f32 v[170:171], v[170:171], v[46:47]
    v_pk_mul_f32 v[184:185], v[184:185], v[48:49]
    v_pk_mul_f32 v[186:187], v[186:187], v[50:51]
    v_cvt_pk_bf16_f32 v44, v168, v169
    v_cvt_pk_bf16_f32 v45, v232, v233
    v_cvt_pk_bf16_f32 v46, v170, v171
    v_cvt_pk_bf16_f32 v47, v234, v235
    v_cvt_pk_bf16_f32 v48, v184, v185
    v_cvt_pk_bf16_f32 v49, v248, v249
    v_cvt_pk_bf16_f32 v50, v186, v187
    v_cvt_pk_bf16_f32 v51, v250, v251
    v_lshlrev_b32 v168, 16, v44
    v_and_b32 v169, 0xffff0000, v44
    v_lshlrev_b32 v170, 16, v46
    v_and_b32 v171, 0xffff0000, v46
    v_lshlrev_b32 v184, 16, v48
    v_and_b32 v185, 0xffff0000, v48
    v_lshlrev_b32 v186, 16, v50
    v_and_b32 v187, 0xffff0000, v50
    v_lshlrev_b32 v232, 16, v45
    v_and_b32 v233, 0xffff0000, v45
    v_lshlrev_b32 v234, 16, v47
    v_and_b32 v235, 0xffff0000, v47
    v_lshlrev_b32 v248, 16, v49
    v_and_b32 v249, 0xffff0000, v49
    v_lshlrev_b32 v250, 16, v51
    v_and_b32 v251, 0xffff0000, v51
    v_pk_mul_f32 v[168:169], v[168:169], v[232:233]
    v_pk_mul_f32 v[170:171], v[170:171], v[234:235]
    v_pk_mul_f32 v[184:185], v[184:185], v[248:249]
    v_pk_mul_f32 v[186:187], v[186:187], v[250:251]
    v_cvt_pk_bf16_f32 v168, v168, v169
    v_cvt_pk_bf16_f32 v169, v170, v171
    v_cvt_pk_bf16_f32 v170, v184, v185
    v_cvt_pk_bf16_f32 v171, v186, v187
    s_add_u32 s53, s52, 0x1c400
    buffer_store_dwordx4 v[168:171], v40, s[24:27], s53 offen
    v_cvt_pk_bf16_f32 v44, v140, v141
    v_cvt_pk_bf16_f32 v46, v142, v143
    v_cvt_pk_bf16_f32 v48, v156, v157
    v_cvt_pk_bf16_f32 v50, v158, v159
    v_lshlrev_b32 v140, 16, v44
    v_and_b32 v141, 0xffff0000, v44
    v_lshlrev_b32 v142, 16, v46
    v_and_b32 v143, 0xffff0000, v46
    v_lshlrev_b32 v156, 16, v48
    v_and_b32 v157, 0xffff0000, v48
    v_lshlrev_b32 v158, 16, v50
    v_and_b32 v159, 0xffff0000, v50
    v_pk_mul_f32 v[44:45], v[140:141], s[60:61]
    v_pk_mul_f32 v[46:47], v[142:143], s[60:61]
    v_pk_mul_f32 v[48:49], v[156:157], s[60:61]
    v_pk_mul_f32 v[50:51], v[158:159], s[60:61]
    v_exp_f32 v44, v44
    v_exp_f32 v45, v45
    v_exp_f32 v46, v46
    v_exp_f32 v47, v47
    v_exp_f32 v48, v48
    v_exp_f32 v49, v49
    v_exp_f32 v50, v50
    v_exp_f32 v51, v51
    v_pk_add_f32 v[44:45], v[44:45], s[62:63]
    v_pk_add_f32 v[46:47], v[46:47], s[62:63]
    v_pk_add_f32 v[48:49], v[48:49], s[62:63]
    v_pk_add_f32 v[50:51], v[50:51], s[62:63]
    v_rcp_f32 v44, v44
    v_rcp_f32 v45, v45
    v_rcp_f32 v46, v46
    v_rcp_f32 v47, v47
    v_rcp_f32 v48, v48
    v_rcp_f32 v49, v49
    v_rcp_f32 v50, v50
    v_rcp_f32 v51, v51
    v_pk_mul_f32 v[140:141], v[140:141], v[44:45]
    v_pk_mul_f32 v[142:143], v[142:143], v[46:47]
    v_pk_mul_f32 v[156:157], v[156:157], v[48:49]
    v_pk_mul_f32 v[158:159], v[158:159], v[50:51]
    v_cvt_pk_bf16_f32 v44, v140, v141
    v_cvt_pk_bf16_f32 v45, v204, v205
    v_cvt_pk_bf16_f32 v46, v142, v143
    v_cvt_pk_bf16_f32 v47, v206, v207
    v_cvt_pk_bf16_f32 v48, v156, v157
    v_cvt_pk_bf16_f32 v49, v220, v221
    v_cvt_pk_bf16_f32 v50, v158, v159
    v_cvt_pk_bf16_f32 v51, v222, v223
    v_lshlrev_b32 v140, 16, v44
    v_and_b32 v141, 0xffff0000, v44
    v_lshlrev_b32 v142, 16, v46
    v_and_b32 v143, 0xffff0000, v46
    v_lshlrev_b32 v156, 16, v48
    v_and_b32 v157, 0xffff0000, v48
    v_lshlrev_b32 v158, 16, v50
    v_and_b32 v159, 0xffff0000, v50
    v_lshlrev_b32 v204, 16, v45
    v_and_b32 v205, 0xffff0000, v45
    v_lshlrev_b32 v206, 16, v47
    v_and_b32 v207, 0xffff0000, v47
    v_lshlrev_b32 v220, 16, v49
    v_and_b32 v221, 0xffff0000, v49
    v_lshlrev_b32 v222, 16, v51
    v_and_b32 v223, 0xffff0000, v51
    v_pk_mul_f32 v[140:141], v[140:141], v[204:205]
    v_pk_mul_f32 v[142:143], v[142:143], v[206:207]
    v_pk_mul_f32 v[156:157], v[156:157], v[220:221]
    v_pk_mul_f32 v[158:159], v[158:159], v[222:223]
    v_cvt_pk_bf16_f32 v140, v140, v141
    v_cvt_pk_bf16_f32 v141, v142, v143
    v_cvt_pk_bf16_f32 v142, v156, v157
    v_cvt_pk_bf16_f32 v143, v158, v159
    s_add_u32 s53, s52, 0x2a000
    buffer_store_dwordx4 v[140:143], v40, s[24:27], s53 offen
    v_cvt_pk_bf16_f32 v44, v172, v173
    v_cvt_pk_bf16_f32 v46, v174, v175
    v_cvt_pk_bf16_f32 v48, v188, v189
    v_cvt_pk_bf16_f32 v50, v190, v191
    v_lshlrev_b32 v172, 16, v44
    v_and_b32 v173, 0xffff0000, v44
    v_lshlrev_b32 v174, 16, v46
    v_and_b32 v175, 0xffff0000, v46
    v_lshlrev_b32 v188, 16, v48
    v_and_b32 v189, 0xffff0000, v48
    v_lshlrev_b32 v190, 16, v50
    v_and_b32 v191, 0xffff0000, v50
    v_pk_mul_f32 v[44:45], v[172:173], s[60:61]
    v_pk_mul_f32 v[46:47], v[174:175], s[60:61]
    v_pk_mul_f32 v[48:49], v[188:189], s[60:61]
    v_pk_mul_f32 v[50:51], v[190:191], s[60:61]
    v_exp_f32 v44, v44
    v_exp_f32 v45, v45
    v_exp_f32 v46, v46
    v_exp_f32 v47, v47
    v_exp_f32 v48, v48
    v_exp_f32 v49, v49
    v_exp_f32 v50, v50
    v_exp_f32 v51, v51
    v_pk_add_f32 v[44:45], v[44:45], s[62:63]
    v_pk_add_f32 v[46:47], v[46:47], s[62:63]
    v_pk_add_f32 v[48:49], v[48:49], s[62:63]
    v_pk_add_f32 v[50:51], v[50:51], s[62:63]
    v_rcp_f32 v44, v44
    v_rcp_f32 v45, v45
    v_rcp_f32 v46, v46
    v_rcp_f32 v47, v47
    v_rcp_f32 v48, v48
    v_rcp_f32 v49, v49
    v_rcp_f32 v50, v50
    v_rcp_f32 v51, v51
    v_pk_mul_f32 v[172:173], v[172:173], v[44:45]
    v_pk_mul_f32 v[174:175], v[174:175], v[46:47]
    v_pk_mul_f32 v[188:189], v[188:189], v[48:49]
    v_pk_mul_f32 v[190:191], v[190:191], v[50:51]
    v_cvt_pk_bf16_f32 v44, v172, v173
    v_cvt_pk_bf16_f32 v45, v236, v237
    v_cvt_pk_bf16_f32 v46, v174, v175
    v_cvt_pk_bf16_f32 v47, v238, v239
    v_cvt_pk_bf16_f32 v48, v188, v189
    v_cvt_pk_bf16_f32 v49, v252, v253
    v_cvt_pk_bf16_f32 v50, v190, v191
    v_cvt_pk_bf16_f32 v51, v254, v255
    v_lshlrev_b32 v172, 16, v44
    v_and_b32 v173, 0xffff0000, v44
    v_lshlrev_b32 v174, 16, v46
    v_and_b32 v175, 0xffff0000, v46
    v_lshlrev_b32 v188, 16, v48
    v_and_b32 v189, 0xffff0000, v48
    v_lshlrev_b32 v190, 16, v50
    v_and_b32 v191, 0xffff0000, v50
    v_lshlrev_b32 v236, 16, v45
    v_and_b32 v237, 0xffff0000, v45
    v_lshlrev_b32 v238, 16, v47
    v_and_b32 v239, 0xffff0000, v47
    v_lshlrev_b32 v252, 16, v49
    v_and_b32 v253, 0xffff0000, v49
    v_lshlrev_b32 v254, 16, v51
    v_and_b32 v255, 0xffff0000, v51
    v_pk_mul_f32 v[172:173], v[172:173], v[236:237]
    v_pk_mul_f32 v[174:175], v[174:175], v[238:239]
    v_pk_mul_f32 v[188:189], v[188:189], v[252:253]
    v_pk_mul_f32 v[190:191], v[190:191], v[254:255]
    v_cvt_pk_bf16_f32 v172, v172, v173
    v_cvt_pk_bf16_f32 v173, v174, v175
    v_cvt_pk_bf16_f32 v174, v188, v189
    v_cvt_pk_bf16_f32 v175, v190, v191
    s_add_u32 s53, s52, 0x2a400
    buffer_store_dwordx4 v[172:175], v40, s[24:27], s53 offen
    s_waitcnt vmcnt(0) lgkmcnt(0)
    s_waitcnt lgkmcnt(0)
L_g1_done:
    s_endpgm
L_g1_wdt:
    s_sub_u32 s2, s2, 224
    s_load_dwordx2 s[10:11], s[0:1], 72
    s_load_dwordx2 s[4:5], s[0:1], 48
    s_mul_i32 s44, s2, 7
    s_mov_b32 s52, 0x05040100
    s_mov_b32 s53, 0x07060302
    v_and_b32 v1, 7, v0
    v_bfe_u32 v2, v0, 3, 2
    v_bfe_u32 v5, v0, 5, 2
    v_lshrrev_b32 v6, 7, v0
    v_lshlrev_b32 v3, 15, v6
    v_lshl_add_u32 v3, v2, 12, v3
    v_lshl_add_u32 v3, v5, 5, v3
    v_lshl_add_u32 v3, v1, 2, v3
    v_mul_u32_u24 v4, 0xe000, v5
    v_lshl_add_u32 v4, v6, 10, v4
    v_lshl_add_u32 v4, v2, 8, v4
    v_lshl_add_u32 v4, v1, 5, v4
    s_add_u32 s45, s44, 0
    s_lshr_b32 s46, s45, 3
    s_and_b32 s47, s45, 7
    s_lshl_b32 s56, s46, 16
    s_lshl_b32 s49, s47, 7
    s_add_u32 s56, s56, s49
    s_add_u32 s57, s56, 0x4000
    s_mul_i32 s58, s47, 0x38000
    s_lshl_b32 s49, s46, 11
    s_add_u32 s58, s58, s49
    s_add_u32 s45, s44, 1
    s_lshr_b32 s46, s45, 3
    s_and_b32 s47, s45, 7
    s_lshl_b32 s59, s46, 16
    s_lshl_b32 s49, s47, 7
    s_add_u32 s59, s59, s49
    s_add_u32 s60, s59, 0x4000
    s_mul_i32 s61, s47, 0x38000
    s_lshl_b32 s49, s46, 11
    s_add_u32 s61, s61, s49
    s_add_u32 s45, s44, 2
    s_lshr_b32 s46, s45, 3
    s_and_b32 s47, s45, 7
    s_lshl_b32 s62, s46, 16
    s_lshl_b32 s49, s47, 7
    s_add_u32 s62, s62, s49
    s_add_u32 s63, s62, 0x4000
    s_mul_i32 s64, s47, 0x38000
    s_lshl_b32 s49, s46, 11
    s_add_u32 s64, s64, s49
    s_add_u32 s45, s44, 3
    s_lshr_b32 s46, s45, 3
    s_and_b32 s47, s45, 7
    s_lshl_b32 s65, s46, 16
    s_lshl_b32 s49, s47, 7
    s_add_u32 s65, s65, s49
    s_add_u32 s66, s65, 0x4000
    s_mul_i32 s67, s47, 0x38000
    s_lshl_b32 s49, s46, 11
    s_add_u32 s67, s67, s49
    s_add_u32 s45, s44, 4
    s_lshr_b32 s46, s45, 3
    s_and_b32 s47, s45, 7
    s_lshl_b32 s68, s46, 16
    s_lshl_b32 s49, s47, 7
    s_add_u32 s68, s68, s49
    s_add_u32 s69, s68, 0x4000
    s_mul_i32 s70, s47, 0x38000
    s_lshl_b32 s49, s46, 11
    s_add_u32 s70, s70, s49
    s_add_u32 s45, s44, 5
    s_lshr_b32 s46, s45, 3
    s_and_b32 s47, s45, 7
    s_lshl_b32 s71, s46, 16
    s_lshl_b32 s49, s47, 7
    s_add_u32 s71, s71, s49
    s_add_u32 s72, s71, 0x4000
    s_mul_i32 s73, s47, 0x38000
    s_lshl_b32 s49, s46, 11
    s_add_u32 s73, s73, s49
    s_add_u32 s45, s44, 6
    s_lshr_b32 s46, s45, 3
    s_and_b32 s47, s45, 7
    s_lshl_b32 s74, s46, 16
    s_lshl_b32 s49, s47, 7
    s_add_u32 s74, s74, s49
    s_add_u32 s75, s74, 0x4000
    s_mul_i32 s76, s47, 0x38000
    s_lshl_b32 s49, s46, 11
    s_add_u32 s76, s76, s49
    s_waitcnt lgkmcnt(0)
    s_mov_b32 s12, s4
    s_mov_b32 s13, s5
    s_mov_b32 s14, 0x1c0000
    s_mov_b32 s15, 0x00020000
    s_add_u32 s16, s10, 0x1400000
    s_addc_u32 s17, s11, 0
    s_mov_b32 s18, 0x1c0000
    s_mov_b32 s19, 0x00020000
    buffer_load_dword v10, v3, s[12:15], s56 offen offset:0
    buffer_load_dword v11, v3, s[12:15], s56 offen offset:1024
    buffer_load_dword v12, v3, s[12:15], s56 offen offset:2048
    buffer_load_dword v13, v3, s[12:15], s56 offen offset:3072
    buffer_load_dword v14, v3, s[12:15], s57 offen offset:0
    buffer_load_dword v15, v3, s[12:15], s57 offen offset:1024
    buffer_load_dword v16, v3, s[12:15], s57 offen offset:2048
    buffer_load_dword v17, v3, s[12:15], s57 offen offset:3072
    buffer_load_dword v18, v3, s[12:15], s59 offen offset:0
    buffer_load_dword v19, v3, s[12:15], s59 offen offset:1024
    buffer_load_dword v20, v3, s[12:15], s59 offen offset:2048
    buffer_load_dword v21, v3, s[12:15], s59 offen offset:3072
    buffer_load_dword v22, v3, s[12:15], s60 offen offset:0
    buffer_load_dword v23, v3, s[12:15], s60 offen offset:1024
    buffer_load_dword v24, v3, s[12:15], s60 offen offset:2048
    buffer_load_dword v25, v3, s[12:15], s60 offen offset:3072
    buffer_load_dword v26, v3, s[12:15], s62 offen offset:0
    buffer_load_dword v27, v3, s[12:15], s62 offen offset:1024
    buffer_load_dword v28, v3, s[12:15], s62 offen offset:2048
    buffer_load_dword v29, v3, s[12:15], s62 offen offset:3072
    buffer_load_dword v30, v3, s[12:15], s63 offen offset:0
    buffer_load_dword v31, v3, s[12:15], s63 offen offset:1024
    buffer_load_dword v32, v3, s[12:15], s63 offen offset:2048
    buffer_load_dword v33, v3, s[12:15], s63 offen offset:3072
    buffer_load_dword v34, v3, s[12:15], s65 offen offset:0
    buffer_load_dword v35, v3, s[12:15], s65 offen offset:1024
    buffer_load_dword v36, v3, s[12:15], s65 offen offset:2048
    buffer_load_dword v37, v3, s[12:15], s65 offen offset:3072
    buffer_load_dword v38, v3, s[12:15], s66 offen offset:0
    buffer_load_dword v39, v3, s[12:15], s66 offen offset:1024
    buffer_load_dword v40, v3, s[12:15], s66 offen offset:2048
    buffer_load_dword v41, v3, s[12:15], s66 offen offset:3072
    buffer_load_dword v42, v3, s[12:15], s68 offen offset:0
    buffer_load_dword v43, v3, s[12:15], s68 offen offset:1024
    buffer_load_dword v44, v3, s[12:15], s68 offen offset:2048
    buffer_load_dword v45, v3, s[12:15], s68 offen offset:3072
    buffer_load_dword v46, v3, s[12:15], s69 offen offset:0
    buffer_load_dword v47, v3, s[12:15], s69 offen offset:1024
    buffer_load_dword v48, v3, s[12:15], s69 offen offset:2048
    buffer_load_dword v49, v3, s[12:15], s69 offen offset:3072
    buffer_load_dword v50, v3, s[12:15], s71 offen offset:0
    buffer_load_dword v51, v3, s[12:15], s71 offen offset:1024
    buffer_load_dword v52, v3, s[12:15], s71 offen offset:2048
    buffer_load_dword v53, v3, s[12:15], s71 offen offset:3072
    buffer_load_dword v54, v3, s[12:15], s72 offen offset:0
    buffer_load_dword v55, v3, s[12:15], s72 offen offset:1024
    buffer_load_dword v56, v3, s[12:15], s72 offen offset:2048
    buffer_load_dword v57, v3, s[12:15], s72 offen offset:3072
    buffer_load_dword v58, v3, s[12:15], s74 offen offset:0
    buffer_load_dword v59, v3, s[12:15], s74 offen offset:1024
    buffer_load_dword v60, v3, s[12:15], s74 offen offset:2048
    buffer_load_dword v61, v3, s[12:15], s74 offen offset:3072
    buffer_load_dword v62, v3, s[12:15], s75 offen offset:0
    buffer_load_dword v63, v3, s[12:15], s75 offen offset:1024
    buffer_load_dword v64, v3, s[12:15], s75 offen offset:2048
    buffer_load_dword v65, v3, s[12:15], s75 offen offset:3072
    s_waitcnt vmcnt(0)
    v_perm_b32 v70, v11, v10, s52
    v_perm_b32 v71, v13, v12, s52
    v_perm_b32 v72, v15, v14, s52
    v_perm_b32 v73, v17, v16, s52
    v_perm_b32 v74, v11, v10, s53
    v_perm_b32 v75, v13, v12, s53
    v_perm_b32 v76, v15, v14, s53
    v_perm_b32 v77, v17, v16, s53
    buffer_store_dwordx4 v[70:73], v4, s[16:19], s58 offen
    buffer_store_dwordx4 v[74:77], v4, s[16:19], s58 offen offset:16
    v_perm_b32 v78, v19, v18, s52
    v_perm_b32 v79, v21, v20, s52
    v_perm_b32 v80, v23, v22, s52
    v_perm_b32 v81, v25, v24, s52
    v_perm_b32 v82, v19, v18, s53
    v_perm_b32 v83, v21, v20, s53
    v_perm_b32 v84, v23, v22, s53
    v_perm_b32 v85, v25, v24, s53
    buffer_store_dwordx4 v[78:81], v4, s[16:19], s61 offen
    buffer_store_dwordx4 v[82:85], v4, s[16:19], s61 offen offset:16
    v_perm_b32 v86, v27, v26, s52
    v_perm_b32 v87, v29, v28, s52
    v_perm_b32 v88, v31, v30, s52
    v_perm_b32 v89, v33, v32, s52
    v_perm_b32 v90, v27, v26, s53
    v_perm_b32 v91, v29, v28, s53
    v_perm_b32 v92, v31, v30, s53
    v_perm_b32 v93, v33, v32, s53
    buffer_store_dwordx4 v[86:89], v4, s[16:19], s64 offen
    buffer_store_dwordx4 v[90:93], v4, s[16:19], s64 offen offset:16
    v_perm_b32 v94, v35, v34, s52
    v_perm_b32 v95, v37, v36, s52
    v_perm_b32 v96, v39, v38, s52
    v_perm_b32 v97, v41, v40, s52
    v_perm_b32 v98, v35, v34, s53
    v_perm_b32 v99, v37, v36, s53
    v_perm_b32 v100, v39, v38, s53
    v_perm_b32 v101, v41, v40, s53
    buffer_store_dwordx4 v[94:97], v4, s[16:19], s67 offen
    buffer_store_dwordx4 v[98:101], v4, s[16:19], s67 offen offset:16
    v_perm_b32 v102, v43, v42, s52
    v_perm_b32 v103, v45, v44, s52
    v_perm_b32 v104, v47, v46, s52
    v_perm_b32 v105, v49, v48, s52
    v_perm_b32 v106, v43, v42, s53
    v_perm_b32 v107, v45, v44, s53
    v_perm_b32 v108, v47, v46, s53
    v_perm_b32 v109, v49, v48, s53
    buffer_store_dwordx4 v[102:105], v4, s[16:19], s70 offen
    buffer_store_dwordx4 v[106:109], v4, s[16:19], s70 offen offset:16
    v_perm_b32 v110, v51, v50, s52
    v_perm_b32 v111, v53, v52, s52
    v_perm_b32 v112, v55, v54, s52
    v_perm_b32 v113, v57, v56, s52
    v_perm_b32 v114, v51, v50, s53
    v_perm_b32 v115, v53, v52, s53
    v_perm_b32 v116, v55, v54, s53
    v_perm_b32 v117, v57, v56, s53
    buffer_store_dwordx4 v[110:113], v4, s[16:19], s73 offen
    buffer_store_dwordx4 v[114:117], v4, s[16:19], s73 offen offset:16
    v_perm_b32 v118, v59, v58, s52
    v_perm_b32 v119, v61, v60, s52
    v_perm_b32 v120, v63, v62, s52
    v_perm_b32 v121, v65, v64, s52
    v_perm_b32 v122, v59, v58, s53
    v_perm_b32 v123, v61, v60, s53
    v_perm_b32 v124, v63, v62, s53
    v_perm_b32 v125, v65, v64, s53
    buffer_store_dwordx4 v[118:121], v4, s[16:19], s76 offen
    buffer_store_dwordx4 v[122:125], v4, s[16:19], s76 offen offset:16
    s_load_dwordx4 s[84:87], s[0:1], 8
    s_add_u32 s80, s10, 0x500000
    s_addc_u32 s81, s11, 0
    s_mov_b32 s82, 0x202000
    s_mov_b32 s83, 0x00020000
    s_mul_i32 s96, s2, 32896
    v_lshlrev_b32 v130, 4, v0
    v_add_u32 v131, 0x9000, v130
    s_waitcnt lgkmcnt(0)
    s_mov_b32 s88, s84
    s_mov_b32 s89, s85
    s_mov_b32 s90, 0x101000
    s_mov_b32 s91, 0x00020000
    s_mov_b32 s92, s86
    s_mov_b32 s93, s87
    s_mov_b32 s94, 0x101000
    s_mov_b32 s95, 0x00020000
    s_add_u32 s97, s96, 0
    buffer_load_dwordx4 v[132:135], v130, s[88:91], s97 offen
    buffer_load_dwordx4 v[168:171], v130, s[92:95], s97 offen
    s_add_u32 s97, s96, 4096
    buffer_load_dwordx4 v[136:139], v130, s[88:91], s97 offen
    buffer_load_dwordx4 v[172:175], v130, s[92:95], s97 offen
    s_add_u32 s97, s96, 8192
    buffer_load_dwordx4 v[140:143], v130, s[88:91], s97 offen
    buffer_load_dwordx4 v[176:179], v130, s[92:95], s97 offen
    s_add_u32 s97, s96, 12288
    buffer_load_dwordx4 v[144:147], v130, s[88:91], s97 offen
    buffer_load_dwordx4 v[180:183], v130, s[92:95], s97 offen
    s_add_u32 s97, s96, 16384
    buffer_load_dwordx4 v[148:151], v130, s[88:91], s97 offen
    buffer_load_dwordx4 v[184:187], v130, s[92:95], s97 offen
    s_add_u32 s97, s96, 20480
    buffer_load_dwordx4 v[152:155], v130, s[88:91], s97 offen
    buffer_load_dwordx4 v[188:191], v130, s[92:95], s97 offen
    s_add_u32 s97, s96, 24576
    buffer_load_dwordx4 v[156:159], v130, s[88:91], s97 offen
    buffer_load_dwordx4 v[192:195], v130, s[92:95], s97 offen
    s_add_u32 s97, s96, 28672
    buffer_load_dwordx4 v[160:163], v130, s[88:91], s97 offen
    buffer_load_dwordx4 v[196:199], v130, s[92:95], s97 offen
    s_add_u32 s97, s96, 32768
    buffer_load_dwordx4 v[164:167], v130, s[88:91], s97 offen
    buffer_load_dwordx4 v[200:203], v130, s[92:95], s97 offen
    s_waitcnt vmcnt(0)
    ds_write_b128 v130, v[132:135] offset:0
    ds_write_b128 v131, v[168:171] offset:0
    ds_write_b128 v130, v[136:139] offset:4096
    ds_write_b128 v131, v[172:175] offset:4096
    ds_write_b128 v130, v[140:143] offset:8192
    ds_write_b128 v131, v[176:179] offset:8192
    ds_write_b128 v130, v[144:147] offset:12288
    ds_write_b128 v131, v[180:183] offset:12288
    ds_write_b128 v130, v[148:151] offset:16384
    ds_write_b128 v131, v[184:187] offset:16384
    ds_write_b128 v130, v[152:155] offset:20480
    ds_write_b128 v131, v[188:191] offset:20480
    ds_write_b128 v130, v[156:159] offset:24576
    ds_write_b128 v131, v[192:195] offset:24576
    ds_write_b128 v130, v[160:163] offset:28672
    ds_write_b128 v131, v[196:199] offset:28672
    ds_write_b128 v130, v[164:167] offset:32768
    ds_write_b128 v131, v[200:203] offset:32768
    v_and_b32 v46, 63, v0
    v_lshrrev_b32 v47, 6, v0
    v_mul_u32_u24 v48, 514, v46
    v_lshl_add_u32 v48, v47, 1, v48
    v_add_u32 v49, 0x9000, v48
    v_lshlrev_b32 v45, 13, v47
    v_lshl_add_u32 v45, v46, 2, v45
    v_readfirstlane_b32 s99, v47
    s_lshl_b32 s98, s2, 8
    s_waitcnt lgkmcnt(0)
    s_barrier
    ds_read_u16 v204, v48 offset:0
    ds_read_u16 v205, v49 offset:0
    ds_read_u16 v206, v48 offset:8
    ds_read_u16 v207, v49 offset:8
    ds_read_u16 v208, v48 offset:16
    ds_read_u16 v209, v49 offset:16
    ds_read_u16 v210, v48 offset:24
    ds_read_u16 v211, v49 offset:24
    ds_read_u16 v212, v48 offset:32
    ds_read_u16 v213, v49 offset:32
    ds_read_u16 v214, v48 offset:40
    ds_read_u16 v215, v49 offset:40
    ds_read_u16 v216, v48 offset:48
    ds_read_u16 v217, v49 offset:48
    ds_read_u16 v218, v48 offset:56
    ds_read_u16 v219, v49 offset:56
    ds_read_u16 v220, v48 offset:64
    ds_read_u16 v221, v49 offset:64
    ds_read_u16 v222, v48 offset:72
    ds_read_u16 v223, v49 offset:72
    ds_read_u16 v224, v48 offset:80
    ds_read_u16 v225, v49 offset:80
    ds_read_u16 v226, v48 offset:88
    ds_read_u16 v227, v49 offset:88
    ds_read_u16 v228, v48 offset:96
    ds_read_u16 v229, v49 offset:96
    ds_read_u16 v230, v48 offset:104
    ds_read_u16 v231, v49 offset:104
    ds_read_u16 v232, v48 offset:112
    ds_read_u16 v233, v49 offset:112
    ds_read_u16 v234, v48 offset:120
    ds_read_u16 v235, v49 offset:120
    s_waitcnt lgkmcnt(0)
    v_lshl_or_b32 v204, v205, 16, v204
    v_lshl_or_b32 v206, v207, 16, v206
    v_lshl_or_b32 v208, v209, 16, v208
    v_lshl_or_b32 v210, v211, 16, v210
    v_lshl_or_b32 v212, v213, 16, v212
    v_lshl_or_b32 v214, v215, 16, v214
    v_lshl_or_b32 v216, v217, 16, v216
    v_lshl_or_b32 v218, v219, 16, v218
    v_lshl_or_b32 v220, v221, 16, v220
    v_lshl_or_b32 v222, v223, 16, v222
    v_lshl_or_b32 v224, v225, 16, v224
    v_lshl_or_b32 v226, v227, 16, v226
    v_lshl_or_b32 v228, v229, 16, v228
    v_lshl_or_b32 v230, v231, 16, v230
    v_lshl_or_b32 v232, v233, 16, v232
    v_lshl_or_b32 v234, v235, 16, v234
    buffer_store_dword v204, v45, s[80:83], s98 offen
    s_add_u32 s98, s98, 0x8000
    buffer_store_dword v206, v45, s[80:83], s98 offen
    s_add_u32 s98, s98, 0x8000
    buffer_store_dword v208, v45, s[80:83], s98 offen
    s_add_u32 s98, s98, 0x8000
    buffer_store_dword v210, v45, s[80:83], s98 offen
    s_add_u32 s98, s98, 0x8000
    buffer_store_dword v212, v45, s[80:83], s98 offen
    s_add_u32 s98, s98, 0x8000
    buffer_store_dword v214, v45, s[80:83], s98 offen
    s_add_u32 s98, s98, 0x8000
    buffer_store_dword v216, v45, s[80:83], s98 offen
    s_add_u32 s98, s98, 0x8000
    buffer_store_dword v218, v45, s[80:83], s98 offen
    s_add_u32 s98, s98, 0x8000
    buffer_store_dword v220, v45, s[80:83], s98 offen
    s_add_u32 s98, s98, 0x8000
    buffer_store_dword v222, v45, s[80:83], s98 offen
    s_add_u32 s98, s98, 0x8000
    buffer_store_dword v224, v45, s[80:83], s98 offen
    s_add_u32 s98, s98, 0x8000
    buffer_store_dword v226, v45, s[80:83], s98 offen
    s_add_u32 s98, s98, 0x8000
    buffer_store_dword v228, v45, s[80:83], s98 offen
    s_add_u32 s98, s98, 0x8000
    buffer_store_dword v230, v45, s[80:83], s98 offen
    s_add_u32 s98, s98, 0x8000
    buffer_store_dword v232, v45, s[80:83], s98 offen
    s_add_u32 s98, s98, 0x8000
    buffer_store_dword v234, v45, s[80:83], s98 offen
    s_add_u32 s98, s98, 0x8000
    ds_read_u16 v132, v48 offset:128
    ds_read_u16 v133, v49 offset:128
    ds_read_u16 v134, v48 offset:136
    ds_read_u16 v135, v49 offset:136
    ds_read_u16 v136, v48 offset:144
    ds_read_u16 v137, v49 offset:144
    ds_read_u16 v138, v48 offset:152
    ds_read_u16 v139, v49 offset:152
    ds_read_u16 v140, v48 offset:160
    ds_read_u16 v141, v49 offset:160
    ds_read_u16 v142, v48 offset:168
    ds_read_u16 v143, v49 offset:168
    ds_read_u16 v144, v48 offset:176
    ds_read_u16 v145, v49 offset:176
    ds_read_u16 v146, v48 offset:184
    ds_read_u16 v147, v49 offset:184
    ds_read_u16 v148, v48 offset:192
    ds_read_u16 v149, v49 offset:192
    ds_read_u16 v150, v48 offset:200
    ds_read_u16 v151, v49 offset:200
    ds_read_u16 v152, v48 offset:208
    ds_read_u16 v153, v49 offset:208
    ds_read_u16 v154, v48 offset:216
    ds_read_u16 v155, v49 offset:216
    ds_read_u16 v156, v48 offset:224
    ds_read_u16 v157, v49 offset:224
    ds_read_u16 v158, v48 offset:232
    ds_read_u16 v159, v49 offset:232
    ds_read_u16 v160, v48 offset:240
    ds_read_u16 v161, v49 offset:240
    ds_read_u16 v162, v48 offset:248
    ds_read_u16 v163, v49 offset:248
    s_waitcnt lgkmcnt(0)
    v_lshl_or_b32 v132, v133, 16, v132
    v_lshl_or_b32 v134, v135, 16, v134
    v_lshl_or_b32 v136, v137, 16, v136
    v_lshl_or_b32 v138, v139, 16, v138
    v_lshl_or_b32 v140, v141, 16, v140
    v_lshl_or_b32 v142, v143, 16, v142
    v_lshl_or_b32 v144, v145, 16, v144
    v_lshl_or_b32 v146, v147, 16, v146
    v_lshl_or_b32 v148, v149, 16, v148
    v_lshl_or_b32 v150, v151, 16, v150
    v_lshl_or_b32 v152, v153, 16, v152
    v_lshl_or_b32 v154, v155, 16, v154
    v_lshl_or_b32 v156, v157, 16, v156
    v_lshl_or_b32 v158, v159, 16, v158
    v_lshl_or_b32 v160, v161, 16, v160
    v_lshl_or_b32 v162, v163, 16, v162
    buffer_store_dword v132, v45, s[80:83], s98 offen
    s_add_u32 s98, s98, 0x8000
    buffer_store_dword v134, v45, s[80:83], s98 offen
    s_add_u32 s98, s98, 0x8000
    buffer_store_dword v136, v45, s[80:83], s98 offen
    s_add_u32 s98, s98, 0x8000
    buffer_store_dword v138, v45, s[80:83], s98 offen
    s_add_u32 s98, s98, 0x8000
    buffer_store_dword v140, v45, s[80:83], s98 offen
    s_add_u32 s98, s98, 0x8000
    buffer_store_dword v142, v45, s[80:83], s98 offen
    s_add_u32 s98, s98, 0x8000
    buffer_store_dword v144, v45, s[80:83], s98 offen
    s_add_u32 s98, s98, 0x8000
    buffer_store_dword v146, v45, s[80:83], s98 offen
    s_add_u32 s98, s98, 0x8000
    buffer_store_dword v148, v45, s[80:83], s98 offen
    s_add_u32 s98, s98, 0x8000
    buffer_store_dword v150, v45, s[80:83], s98 offen
    s_add_u32 s98, s98, 0x8000
    buffer_store_dword v152, v45, s[80:83], s98 offen
    s_add_u32 s98, s98, 0x8000
    buffer_store_dword v154, v45, s[80:83], s98 offen
    s_add_u32 s98, s98, 0x8000
    buffer_store_dword v156, v45, s[80:83], s98 offen
    s_add_u32 s98, s98, 0x8000
    buffer_store_dword v158, v45, s[80:83], s98 offen
    s_add_u32 s98, s98, 0x8000
    buffer_store_dword v160, v45, s[80:83], s98 offen
    s_add_u32 s98, s98, 0x8000
    buffer_store_dword v162, v45, s[80:83], s98 offen
    s_add_u32 s98, s98, 0x8000
    ds_read_u16 v164, v48 offset:256
    ds_read_u16 v165, v49 offset:256
    ds_read_u16 v166, v48 offset:264
    ds_read_u16 v167, v49 offset:264
    ds_read_u16 v168, v48 offset:272
    ds_read_u16 v169, v49 offset:272
    ds_read_u16 v170, v48 offset:280
    ds_read_u16 v171, v49 offset:280
    ds_read_u16 v172, v48 offset:288
    ds_read_u16 v173, v49 offset:288
    ds_read_u16 v174, v48 offset:296
    ds_read_u16 v175, v49 offset:296
    ds_read_u16 v176, v48 offset:304
    ds_read_u16 v177, v49 offset:304
    ds_read_u16 v178, v48 offset:312
    ds_read_u16 v179, v49 offset:312
    ds_read_u16 v180, v48 offset:320
    ds_read_u16 v181, v49 offset:320
    ds_read_u16 v182, v48 offset:328
    ds_read_u16 v183, v49 offset:328
    ds_read_u16 v184, v48 offset:336
    ds_read_u16 v185, v49 offset:336
    ds_read_u16 v186, v48 offset:344
    ds_read_u16 v187, v49 offset:344
    ds_read_u16 v188, v48 offset:352
    ds_read_u16 v189, v49 offset:352
    ds_read_u16 v190, v48 offset:360
    ds_read_u16 v191, v49 offset:360
    ds_read_u16 v192, v48 offset:368
    ds_read_u16 v193, v49 offset:368
    ds_read_u16 v194, v48 offset:376
    ds_read_u16 v195, v49 offset:376
    s_waitcnt lgkmcnt(0)
    v_lshl_or_b32 v164, v165, 16, v164
    v_lshl_or_b32 v166, v167, 16, v166
    v_lshl_or_b32 v168, v169, 16, v168
    v_lshl_or_b32 v170, v171, 16, v170
    v_lshl_or_b32 v172, v173, 16, v172
    v_lshl_or_b32 v174, v175, 16, v174
    v_lshl_or_b32 v176, v177, 16, v176
    v_lshl_or_b32 v178, v179, 16, v178
    v_lshl_or_b32 v180, v181, 16, v180
    v_lshl_or_b32 v182, v183, 16, v182
    v_lshl_or_b32 v184, v185, 16, v184
    v_lshl_or_b32 v186, v187, 16, v186
    v_lshl_or_b32 v188, v189, 16, v188
    v_lshl_or_b32 v190, v191, 16, v190
    v_lshl_or_b32 v192, v193, 16, v192
    v_lshl_or_b32 v194, v195, 16, v194
    buffer_store_dword v164, v45, s[80:83], s98 offen
    s_add_u32 s98, s98, 0x8000
    buffer_store_dword v166, v45, s[80:83], s98 offen
    s_add_u32 s98, s98, 0x8000
    buffer_store_dword v168, v45, s[80:83], s98 offen
    s_add_u32 s98, s98, 0x8000
    buffer_store_dword v170, v45, s[80:83], s98 offen
    s_add_u32 s98, s98, 0x8000
    buffer_store_dword v172, v45, s[80:83], s98 offen
    s_add_u32 s98, s98, 0x8000
    buffer_store_dword v174, v45, s[80:83], s98 offen
    s_add_u32 s98, s98, 0x8000
    buffer_store_dword v176, v45, s[80:83], s98 offen
    s_add_u32 s98, s98, 0x8000
    buffer_store_dword v178, v45, s[80:83], s98 offen
    s_add_u32 s98, s98, 0x8000
    buffer_store_dword v180, v45, s[80:83], s98 offen
    s_add_u32 s98, s98, 0x8000
    buffer_store_dword v182, v45, s[80:83], s98 offen
    s_add_u32 s98, s98, 0x8000
    buffer_store_dword v184, v45, s[80:83], s98 offen
    s_add_u32 s98, s98, 0x8000
    buffer_store_dword v186, v45, s[80:83], s98 offen
    s_add_u32 s98, s98, 0x8000
    buffer_store_dword v188, v45, s[80:83], s98 offen
    s_add_u32 s98, s98, 0x8000
    buffer_store_dword v190, v45, s[80:83], s98 offen
    s_add_u32 s98, s98, 0x8000
    buffer_store_dword v192, v45, s[80:83], s98 offen
    s_add_u32 s98, s98, 0x8000
    buffer_store_dword v194, v45, s[80:83], s98 offen
    s_add_u32 s98, s98, 0x8000
    ds_read_u16 v10, v48 offset:384
    ds_read_u16 v11, v49 offset:384
    ds_read_u16 v12, v48 offset:392
    ds_read_u16 v13, v49 offset:392
    ds_read_u16 v14, v48 offset:400
    ds_read_u16 v15, v49 offset:400
    ds_read_u16 v16, v48 offset:408
    ds_read_u16 v17, v49 offset:408
    ds_read_u16 v18, v48 offset:416
    ds_read_u16 v19, v49 offset:416
    ds_read_u16 v20, v48 offset:424
    ds_read_u16 v21, v49 offset:424
    ds_read_u16 v22, v48 offset:432
    ds_read_u16 v23, v49 offset:432
    ds_read_u16 v24, v48 offset:440
    ds_read_u16 v25, v49 offset:440
    ds_read_u16 v26, v48 offset:448
    ds_read_u16 v27, v49 offset:448
    ds_read_u16 v28, v48 offset:456
    ds_read_u16 v29, v49 offset:456
    ds_read_u16 v30, v48 offset:464
    ds_read_u16 v31, v49 offset:464
    ds_read_u16 v32, v48 offset:472
    ds_read_u16 v33, v49 offset:472
    ds_read_u16 v34, v48 offset:480
    ds_read_u16 v35, v49 offset:480
    ds_read_u16 v36, v48 offset:488
    ds_read_u16 v37, v49 offset:488
    ds_read_u16 v38, v48 offset:496
    ds_read_u16 v39, v49 offset:496
    ds_read_u16 v40, v48 offset:504
    ds_read_u16 v41, v49 offset:504
    s_waitcnt lgkmcnt(0)
    v_lshl_or_b32 v10, v11, 16, v10
    v_lshl_or_b32 v12, v13, 16, v12
    v_lshl_or_b32 v14, v15, 16, v14
    v_lshl_or_b32 v16, v17, 16, v16
    v_lshl_or_b32 v18, v19, 16, v18
    v_lshl_or_b32 v20, v21, 16, v20
    v_lshl_or_b32 v22, v23, 16, v22
    v_lshl_or_b32 v24, v25, 16, v24
    v_lshl_or_b32 v26, v27, 16, v26
    v_lshl_or_b32 v28, v29, 16, v28
    v_lshl_or_b32 v30, v31, 16, v30
    v_lshl_or_b32 v32, v33, 16, v32
    v_lshl_or_b32 v34, v35, 16, v34
    v_lshl_or_b32 v36, v37, 16, v36
    v_lshl_or_b32 v38, v39, 16, v38
    v_lshl_or_b32 v40, v41, 16, v40
    buffer_store_dword v10, v45, s[80:83], s98 offen
    s_add_u32 s98, s98, 0x8000
    buffer_store_dword v12, v45, s[80:83], s98 offen
    s_add_u32 s98, s98, 0x8000
    buffer_store_dword v14, v45, s[80:83], s98 offen
    s_add_u32 s98, s98, 0x8000
    buffer_store_dword v16, v45, s[80:83], s98 offen
    s_add_u32 s98, s98, 0x8000
    buffer_store_dword v18, v45, s[80:83], s98 offen
    s_add_u32 s98, s98, 0x8000
    buffer_store_dword v20, v45, s[80:83], s98 offen
    s_add_u32 s98, s98, 0x8000
    buffer_store_dword v22, v45, s[80:83], s98 offen
    s_add_u32 s98, s98, 0x8000
    buffer_store_dword v24, v45, s[80:83], s98 offen
    s_add_u32 s98, s98, 0x8000
    buffer_store_dword v26, v45, s[80:83], s98 offen
    s_add_u32 s98, s98, 0x8000
    buffer_store_dword v28, v45, s[80:83], s98 offen
    s_add_u32 s98, s98, 0x8000
    buffer_store_dword v30, v45, s[80:83], s98 offen
    s_add_u32 s98, s98, 0x8000
    buffer_store_dword v32, v45, s[80:83], s98 offen
    s_add_u32 s98, s98, 0x8000
    buffer_store_dword v34, v45, s[80:83], s98 offen
    s_add_u32 s98, s98, 0x8000
    buffer_store_dword v36, v45, s[80:83], s98 offen
    s_add_u32 s98, s98, 0x8000
    buffer_store_dword v38, v45, s[80:83], s98 offen
    s_add_u32 s98, s98, 0x8000
    buffer_store_dword v40, v45, s[80:83], s98 offen
    s_add_u32 s98, s98, 0x8000
    s_cmp_lg_u32 s99, 0
    s_cbranch_scc1 L_g1_wt_done
    ds_read_u16 v42, v48 offset:512
    ds_read_u16 v43, v49 offset:512
    s_waitcnt lgkmcnt(0)
    v_lshl_or_b32 v42, v43, 16, v42
    buffer_store_dword v42, v45, s[80:83], s98 offen
L_g1_wt_done:
    s_endpgm

.globl gemm2_kernel
.p2align 8
.type gemm2_kernel,@function
gemm2_kernel:
    s_mov_b32 s3, s2
    s_cmp_ge_u32 s2, 513
    s_cbranch_scc1 L_g2_done
    s_cmp_ge_u32 s2, 256
    s_cbranch_scc1 L_g2_cols
    s_load_dwordx2 s[10:11], s[0:1], 72
    s_and_b32 s46, s2, 3
    s_lshl_b32 s46, s46, 3
    s_bfe_u32 s47, s2, 0x30003
    s_add_u32 s46, s46, s47
    s_bfe_u32 s47, s2, 0x10002
    s_lshl_b32 s47, s47, 2
    s_lshr_b32 s48, s2, 6
    s_add_u32 s47, s47, s48
    s_waitcnt lgkmcnt(0)
    s_add_u32 s12, s10, 0xa00000
    s_addc_u32 s13, s11, 0
    s_mov_b32 s14, 0x700000
    s_mov_b32 s15, 0x00020000
    s_add_u32 s16, s10, 0x1400000
    s_addc_u32 s17, s11, 0
    s_mov_b32 s18, 0x1c0000
    s_mov_b32 s19, 0x00020000
    s_add_u32 s24, s10, 0x1200000
    s_addc_u32 s25, s11, 0
    s_mov_b32 s26, 0x200000
    s_mov_b32 s27, 0x00020000
    s_mul_i32 s80, s46, 0x38000
    s_mul_i32 s84, s47, 0x38000
    s_mul_i32 s81, s46, 0x38000
    s_mul_i32 s85, s47, 0x38000
    s_add_u32 s81, s81, 4096
    s_add_u32 s85, s85, 4096
    s_mul_i32 s82, s46, 0x38000
    s_mul_i32 s86, s47, 0x38000
    s_add_u32 s82, s82, 8192
    s_add_u32 s86, s86, 8192
    s_mul_i32 s83, s46, 0x38000
    s_mul_i32 s87, s47, 0x38000
    s_add_u32 s83, s83, 12288
    s_add_u32 s87, s87, 12288
    v_lshrrev_b32 v70, 6, v0
    v_mul_u32_u24 v69, 0x3800, v70
    v_and_b32 v71, 63, v0
    v_lshlrev_b32 v71, 4, v71
    v_add_u32 v64, v71, v69
    v_add_u32 v65, 0xe000, v64
    v_add_u32 v66, 0x1c000, v64
    v_add_u32 v67, 0x2a000, v64
    v_readfirstlane_b32 s54, v70
    v_and_b32 v68, 15, v0
    v_lshl_add_u32 v68, v70, 4, v68
    v_lshlrev_b32 v68, 10, v68
    v_bfe_u32 v69, v0, 4, 2
    v_lshl_add_u32 v70, v69, 3, v68
    buffer_load_dwordx4 v[72:75], v64, s[16:19], s84 offen offset:0
    buffer_load_dwordx4 v[76:79], v64, s[12:15], s80 offen offset:0
    buffer_load_dwordx4 v[80:83], v65, s[16:19], s84 offen offset:0
    buffer_load_dwordx4 v[84:87], v66, s[16:19], s84 offen offset:0
    buffer_load_dwordx4 v[88:91], v67, s[16:19], s84 offen offset:0
    buffer_load_dwordx4 v[92:95], v65, s[12:15], s80 offen offset:0
    buffer_load_dwordx4 v[96:99], v66, s[12:15], s80 offen offset:0
    buffer_load_dwordx4 v[100:103], v67, s[12:15], s80 offen offset:0
    buffer_load_dwordx4 v[104:107], v64, s[16:19], s84 offen offset:1024
    buffer_load_dwordx4 v[108:111], v64, s[12:15], s80 offen offset:1024
    buffer_load_dwordx4 v[112:115], v65, s[16:19], s84 offen offset:1024
    buffer_load_dwordx4 v[116:119], v66, s[16:19], s84 offen offset:1024
    buffer_load_dwordx4 v[120:123], v67, s[16:19], s84 offen offset:1024
    buffer_load_dwordx4 v[124:127], v65, s[12:15], s80 offen offset:1024
    buffer_load_dwordx4 v[128:131], v66, s[12:15], s80 offen offset:1024
    buffer_load_dwordx4 v[132:135], v67, s[12:15], s80 offen offset:1024
    buffer_load_dwordx4 v[136:139], v64, s[16:19], s84 offen offset:2048
    buffer_load_dwordx4 v[140:143], v64, s[12:15], s80 offen offset:2048
    buffer_load_dwordx4 v[144:147], v65, s[16:19], s84 offen offset:2048
    buffer_load_dwordx4 v[148:151], v66, s[16:19], s84 offen offset:2048
    buffer_load_dwordx4 v[152:155], v67, s[16:19], s84 offen offset:2048
    buffer_load_dwordx4 v[156:159], v65, s[12:15], s80 offen offset:2048
    buffer_load_dwordx4 v[160:163], v66, s[12:15], s80 offen offset:2048
    buffer_load_dwordx4 v[164:167], v67, s[12:15], s80 offen offset:2048
    buffer_load_dwordx4 v[168:171], v64, s[16:19], s84 offen offset:3072
    buffer_load_dwordx4 v[172:175], v64, s[12:15], s80 offen offset:3072
    buffer_load_dwordx4 v[176:179], v65, s[16:19], s84 offen offset:3072
    buffer_load_dwordx4 v[180:183], v66, s[16:19], s84 offen offset:3072
    buffer_load_dwordx4 v[184:187], v67, s[16:19], s84 offen offset:3072
    buffer_load_dwordx4 v[188:191], v65, s[12:15], s80 offen offset:3072
    buffer_load_dwordx4 v[192:195], v66, s[12:15], s80 offen offset:3072
    buffer_load_dwordx4 v[196:199], v67, s[12:15], s80 offen offset:3072
    buffer_load_dwordx4 v[200:203], v64, s[16:19], s85 offen offset:0
    buffer_load_dwordx4 v[204:207], v64, s[12:15], s81 offen offset:0
    buffer_load_dwordx4 v[208:211], v65, s[16:19], s85 offen offset:0
    buffer_load_dwordx4 v[212:215], v66, s[16:19], s85 offen offset:0
    buffer_load_dwordx4 v[216:219], v67, s[16:19], s85 offen offset:0
    buffer_load_dwordx4 v[220:223], v65, s[12:15], s81 offen offset:0
    buffer_load_dwordx4 v[224:227], v66, s[12:15], s81 offen offset:0
    buffer_load_dwordx4 v[228:231], v67, s[12:15], s81 offen offset:0
    buffer_load_dwordx4 v[232:235], v64, s[16:19], s85 offen offset:1024
    buffer_load_dwordx4 v[236:239], v64, s[12:15], s81 offen offset:1024
    buffer_load_dwordx4 v[240:243], v65, s[16:19], s85 offen offset:1024
    buffer_load_dwordx4 v[244:247], v66, s[16:19], s85 offen offset:1024
    buffer_load_dwordx4 v[248:251], v67, s[16:19], s85 offen offset:1024
    buffer_load_dwordx4 v[252:255], v65, s[12:15], s81 offen offset:1024
    s_waitcnt vmcnt(44)
    v_mfma_f32_16x16x32_bf16 v[0:3], v[72:75], v[76:79], 0
    s_waitcnt vmcnt(43)
    v_mfma_f32_16x16x32_bf16 v[4:7], v[80:83], v[76:79], 0
    s_waitcnt vmcnt(42)
    v_mfma_f32_16x16x32_bf16 v[8:11], v[84:87], v[76:79], 0
    s_waitcnt vmcnt(41)
    v_mfma_f32_16x16x32_bf16 v[12:15], v[88:91], v[76:79], 0
    buffer_load_dwordx4 v[76:79], v66, s[12:15], s81 offen offset:1024
    s_waitcnt vmcnt(41)
    v_mfma_f32_16x16x32_bf16 v[16:19], v[72:75], v[92:95], 0
    v_mfma_f32_16x16x32_bf16 v[20:23], v[80:83], v[92:95], 0
    v_mfma_f32_16x16x32_bf16 v[24:27], v[84:87], v[92:95], 0
    v_mfma_f32_16x16x32_bf16 v[28:31], v[88:91], v[92:95], 0
    buffer_load_dwordx4 v[92:95], v67, s[12:15], s81 offen offset:1024
    s_waitcnt vmcnt(41)
    v_mfma_f32_16x16x32_bf16 v[32:35], v[72:75], v[96:99], 0
    v_mfma_f32_16x16x32_bf16 v[36:39], v[80:83], v[96:99], 0
    v_mfma_f32_16x16x32_bf16 v[40:43], v[84:87], v[96:99], 0
    v_mfma_f32_16x16x32_bf16 v[44:47], v[88:91], v[96:99], 0
    buffer_load_dwordx4 v[96:99], v64, s[16:19], s85 offen offset:2048
    s_waitcnt vmcnt(41)
    v_mfma_f32_16x16x32_bf16 v[48:51], v[72:75], v[100:103], 0
    buffer_load_dwordx4 v[72:75], v64, s[12:15], s81 offen offset:2048
    v_mfma_f32_16x16x32_bf16 v[52:55], v[80:83], v[100:103], 0
    buffer_load_dwordx4 v[80:83], v65, s[16:19], s85 offen offset:2048
    v_mfma_f32_16x16x32_bf16 v[56:59], v[84:87], v[100:103], 0
    buffer_load_dwordx4 v[84:87], v66, s[16:19], s85 offen offset:2048
    v_mfma_f32_16x16x32_bf16 v[60:63], v[88:91], v[100:103], 0
    buffer_load_dwordx4 v[100:103], v67, s[16:19], s85 offen offset:2048
    buffer_load_dwordx4 v[88:91], v65, s[12:15], s81 offen offset:2048
    s_waitcnt vmcnt(44)
    v_mfma_f32_16x16x32_bf16 v[0:3], v[104:107], v[108:111], v[0:3]
    s_waitcnt vmcnt(43)
    v_mfma_f32_16x16x32_bf16 v[4:7], v[112:115], v[108:111], v[4:7]
    s_waitcnt vmcnt(42)
    v_mfma_f32_16x16x32_bf16 v[8:11], v[116:119], v[108:111], v[8:11]
    s_waitcnt vmcnt(41)
    v_mfma_f32_16x16x32_bf16 v[12:15], v[120:123], v[108:111], v[12:15]
    buffer_load_dwordx4 v[108:111], v66, s[12:15], s81 offen offset:2048
    s_waitcnt vmcnt(41)
    v_mfma_f32_16x16x32_bf16 v[16:19], v[104:107], v[124:127], v[16:19]
    v_mfma_f32_16x16x32_bf16 v[20:23], v[112:115], v[124:127], v[20:23]
    v_mfma_f32_16x16x32_bf16 v[24:27], v[116:119], v[124:127], v[24:27]
    v_mfma_f32_16x16x32_bf16 v[28:31], v[120:123], v[124:127], v[28:31]
    buffer_load_dwordx4 v[124:127], v67, s[12:15], s81 offen offset:2048
    s_waitcnt vmcnt(41)
    v_mfma_f32_16x16x32_bf16 v[32:35], v[104:107], v[128:131], v[32:35]
    v_mfma_f32_16x16x32_bf16 v[36:39], v[112:115], v[128:131], v[36:39]
    v_mfma_f32_16x16x32_bf16 v[40:43], v[116:119], v[128:131], v[40:43]
    v_mfma_f32_16x16x32_bf16 v[44:47], v[120:123], v[128:131], v[44:47]
    buffer_load_dwordx4 v[128:131], v64, s[16:19], s85 offen offset:3072
    s_waitcnt vmcnt(41)
    v_mfma_f32_16x16x32_bf16 v[48:51], v[104:107], v[132:135], v[48:51]
    buffer_load_dwordx4 v[104:107], v64, s[12:15], s81 offen offset:3072
    v_mfma_f32_16x16x32_bf16 v[52:55], v[112:115], v[132:135], v[52:55]
    buffer_load_dwordx4 v[112:115], v65, s[16:19], s85 offen offset:3072
    v_mfma_f32_16x16x32_bf16 v[56:59], v[116:119], v[132:135], v[56:59]
    buffer_load_dwordx4 v[116:119], v66, s[16:19], s85 offen offset:3072
    v_mfma_f32_16x16x32_bf16 v[60:63], v[120:123], v[132:135], v[60:63]
    buffer_load_dwordx4 v[132:135], v67, s[16:19], s85 offen offset:3072
    buffer_load_dwordx4 v[120:123], v65, s[12:15], s81 offen offset:3072
    s_waitcnt vmcnt(44)
    v_mfma_f32_16x16x32_bf16 v[0:3], v[136:139], v[140:143], v[0:3]
    s_waitcnt vmcnt(43)
    v_mfma_f32_16x16x32_bf16 v[4:7], v[144:147], v[140:143], v[4:7]
    s_waitcnt vmcnt(42)
    v_mfma_f32_16x16x32_bf16 v[8:11], v[148:151], v[140:143], v[8:11]
    s_waitcnt vmcnt(41)
    v_mfma_f32_16x16x32_bf16 v[12:15], v[152:155], v[140:143], v[12:15]
    buffer_load_dwordx4 v[140:143], v66, s[12:15], s81 offen offset:3072
    s_waitcnt vmcnt(41)
    v_mfma_f32_16x16x32_bf16 v[16:19], v[136:139], v[156:159], v[16:19]
    v_mfma_f32_16x16x32_bf16 v[20:23], v[144:147], v[156:159], v[20:23]
    v_mfma_f32_16x16x32_bf16 v[24:27], v[148:151], v[156:159], v[24:27]
    v_mfma_f32_16x16x32_bf16 v[28:31], v[152:155], v[156:159], v[28:31]
    buffer_load_dwordx4 v[156:159], v67, s[12:15], s81 offen offset:3072
    s_waitcnt vmcnt(41)
    v_mfma_f32_16x16x32_bf16 v[32:35], v[136:139], v[160:163], v[32:35]
    v_mfma_f32_16x16x32_bf16 v[36:39], v[144:147], v[160:163], v[36:39]
    v_mfma_f32_16x16x32_bf16 v[40:43], v[148:151], v[160:163], v[40:43]
    v_mfma_f32_16x16x32_bf16 v[44:47], v[152:155], v[160:163], v[44:47]
    buffer_load_dwordx4 v[160:163], v64, s[16:19], s86 offen offset:0
    s_waitcnt vmcnt(41)
    v_mfma_f32_16x16x32_bf16 v[48:51], v[136:139], v[164:167], v[48:51]
    buffer_load_dwordx4 v[136:139], v64, s[12:15], s82 offen offset:0
    v_mfma_f32_16x16x32_bf16 v[52:55], v[144:147], v[164:167], v[52:55]
    buffer_load_dwordx4 v[144:147], v65, s[16:19], s86 offen offset:0
    v_mfma_f32_16x16x32_bf16 v[56:59], v[148:151], v[164:167], v[56:59]
    buffer_load_dwordx4 v[148:151], v66, s[16:19], s86 offen offset:0
    v_mfma_f32_16x16x32_bf16 v[60:63], v[152:155], v[164:167], v[60:63]
    buffer_load_dwordx4 v[164:167], v67, s[16:19], s86 offen offset:0
    buffer_load_dwordx4 v[152:155], v65, s[12:15], s82 offen offset:0
    s_waitcnt vmcnt(44)
    v_mfma_f32_16x16x32_bf16 v[0:3], v[168:171], v[172:175], v[0:3]
    s_waitcnt vmcnt(43)
    v_mfma_f32_16x16x32_bf16 v[4:7], v[176:179], v[172:175], v[4:7]
    s_waitcnt vmcnt(42)
    v_mfma_f32_16x16x32_bf16 v[8:11], v[180:183], v[172:175], v[8:11]
    s_waitcnt vmcnt(41)
    v_mfma_f32_16x16x32_bf16 v[12:15], v[184:187], v[172:175], v[12:15]
    buffer_load_dwordx4 v[172:175], v66, s[12:15], s82 offen offset:0
    s_waitcnt vmcnt(41)
    v_mfma_f32_16x16x32_bf16 v[16:19], v[168:171], v[188:191], v[16:19]
    v_mfma_f32_16x16x32_bf16 v[20:23], v[176:179], v[188:191], v[20:23]
    v_mfma_f32_16x16x32_bf16 v[24:27], v[180:183], v[188:191], v[24:27]
    v_mfma_f32_16x16x32_bf16 v[28:31], v[184:187], v[188:191], v[28:31]
    buffer_load_dwordx4 v[188:191], v67, s[12:15], s82 offen offset:0
    s_waitcnt vmcnt(41)
    v_mfma_f32_16x16x32_bf16 v[32:35], v[168:171], v[192:195], v[32:35]
    v_mfma_f32_16x16x32_bf16 v[36:39], v[176:179], v[192:195], v[36:39]
    v_mfma_f32_16x16x32_bf16 v[40:43], v[180:183], v[192:195], v[40:43]
    v_mfma_f32_16x16x32_bf16 v[44:47], v[184:187], v[192:195], v[44:47]
    buffer_load_dwordx4 v[192:195], v64, s[16:19], s86 offen offset:1024
    s_waitcnt vmcnt(41)
    v_mfma_f32_16x16x32_bf16 v[48:51], v[168:171], v[196:199], v[48:51]
    buffer_load_dwordx4 v[168:171], v64, s[12:15], s82 offen offset:1024
    v_mfma_f32_16x16x32_bf16 v[52:55], v[176:179], v[196:199], v[52:55]
    buffer_load_dwordx4 v[176:179], v65, s[16:19], s86 offen offset:1024
    v_mfma_f32_16x16x32_bf16 v[56:59], v[180:183], v[196:199], v[56:59]
    buffer_load_dwordx4 v[180:183], v66, s[16:19], s86 offen offset:1024
    v_mfma_f32_16x16x32_bf16 v[60:63], v[184:187], v[196:199], v[60:63]
    buffer_load_dwordx4 v[196:199], v67, s[16:19], s86 offen offset:1024
    buffer_load_dwordx4 v[184:187], v65, s[12:15], s82 offen offset:1024
    s_waitcnt vmcnt(44)
    v_mfma_f32_16x16x32_bf16 v[0:3], v[200:203], v[204:207], v[0:3]
    s_waitcnt vmcnt(43)
    v_mfma_f32_16x16x32_bf16 v[4:7], v[208:211], v[204:207], v[4:7]
    s_waitcnt vmcnt(42)
    v_mfma_f32_16x16x32_bf16 v[8:11], v[212:215], v[204:207], v[8:11]
    s_waitcnt vmcnt(41)
    v_mfma_f32_16x16x32_bf16 v[12:15], v[216:219], v[204:207], v[12:15]
    buffer_load_dwordx4 v[204:207], v66, s[12:15], s82 offen offset:1024
    s_waitcnt vmcnt(41)
    v_mfma_f32_16x16x32_bf16 v[16:19], v[200:203], v[220:223], v[16:19]
    v_mfma_f32_16x16x32_bf16 v[20:23], v[208:211], v[220:223], v[20:23]
    v_mfma_f32_16x16x32_bf16 v[24:27], v[212:215], v[220:223], v[24:27]
    v_mfma_f32_16x16x32_bf16 v[28:31], v[216:219], v[220:223], v[28:31]
    buffer_load_dwordx4 v[220:223], v67, s[12:15], s82 offen offset:1024
    s_waitcnt vmcnt(41)
    v_mfma_f32_16x16x32_bf16 v[32:35], v[200:203], v[224:227], v[32:35]
    v_mfma_f32_16x16x32_bf16 v[36:39], v[208:211], v[224:227], v[36:39]
    v_mfma_f32_16x16x32_bf16 v[40:43], v[212:215], v[224:227], v[40:43]
    v_mfma_f32_16x16x32_bf16 v[44:47], v[216:219], v[224:227], v[44:47]
    buffer_load_dwordx4 v[224:227], v64, s[16:19], s86 offen offset:2048
    s_waitcnt vmcnt(41)
    v_mfma_f32_16x16x32_bf16 v[48:51], v[200:203], v[228:231], v[48:51]
    buffer_load_dwordx4 v[200:203], v64, s[12:15], s82 offen offset:2048
    v_mfma_f32_16x16x32_bf16 v[52:55], v[208:211], v[228:231], v[52:55]
    buffer_load_dwordx4 v[208:211], v65, s[16:19], s86 offen offset:2048
    v_mfma_f32_16x16x32_bf16 v[56:59], v[212:215], v[228:231], v[56:59]
    buffer_load_dwordx4 v[212:215], v66, s[16:19], s86 offen offset:2048
    v_mfma_f32_16x16x32_bf16 v[60:63], v[216:219], v[228:231], v[60:63]
    buffer_load_dwordx4 v[228:231], v67, s[16:19], s86 offen offset:2048
    buffer_load_dwordx4 v[216:219], v65, s[12:15], s82 offen offset:2048
    s_waitcnt vmcnt(44)
    v_mfma_f32_16x16x32_bf16 v[0:3], v[232:235], v[236:239], v[0:3]
    s_waitcnt vmcnt(43)
    v_mfma_f32_16x16x32_bf16 v[4:7], v[240:243], v[236:239], v[4:7]
    s_waitcnt vmcnt(42)
    v_mfma_f32_16x16x32_bf16 v[8:11], v[244:247], v[236:239], v[8:11]
    s_waitcnt vmcnt(41)
    v_mfma_f32_16x16x32_bf16 v[12:15], v[248:251], v[236:239], v[12:15]
    buffer_load_dwordx4 v[236:239], v66, s[12:15], s82 offen offset:2048
    s_waitcnt vmcnt(41)
    v_mfma_f32_16x16x32_bf16 v[16:19], v[232:235], v[252:255], v[16:19]
    v_mfma_f32_16x16x32_bf16 v[20:23], v[240:243], v[252:255], v[20:23]
    v_mfma_f32_16x16x32_bf16 v[24:27], v[244:247], v[252:255], v[24:27]
    v_mfma_f32_16x16x32_bf16 v[28:31], v[248:251], v[252:255], v[28:31]
    buffer_load_dwordx4 v[252:255], v67, s[12:15], s82 offen offset:2048
    s_waitcnt vmcnt(41)
    v_mfma_f32_16x16x32_bf16 v[32:35], v[232:235], v[76:79], v[32:35]
    v_mfma_f32_16x16x32_bf16 v[36:39], v[240:243], v[76:79], v[36:39]
    v_mfma_f32_16x16x32_bf16 v[40:43], v[244:247], v[76:79], v[40:43]
    v_mfma_f32_16x16x32_bf16 v[44:47], v[248:251], v[76:79], v[44:47]
    buffer_load_dwordx4 v[76:79], v64, s[16:19], s86 offen offset:3072
    s_waitcnt vmcnt(41)
    v_mfma_f32_16x16x32_bf16 v[48:51], v[232:235], v[92:95], v[48:51]
    buffer_load_dwordx4 v[232:235], v64, s[12:15], s82 offen offset:3072
    v_mfma_f32_16x16x32_bf16 v[52:55], v[240:243], v[92:95], v[52:55]
    buffer_load_dwordx4 v[240:243], v65, s[16:19], s86 offen offset:3072
    v_mfma_f32_16x16x32_bf16 v[56:59], v[244:247], v[92:95], v[56:59]
    buffer_load_dwordx4 v[244:247], v66, s[16:19], s86 offen offset:3072
    v_mfma_f32_16x16x32_bf16 v[60:63], v[248:251], v[92:95], v[60:63]
    buffer_load_dwordx4 v[92:95], v67, s[16:19], s86 offen offset:3072
    buffer_load_dwordx4 v[248:251], v65, s[12:15], s82 offen offset:3072
    s_waitcnt vmcnt(44)
    v_mfma_f32_16x16x32_bf16 v[0:3], v[96:99], v[72:75], v[0:3]
    s_waitcnt vmcnt(43)
    v_mfma_f32_16x16x32_bf16 v[4:7], v[80:83], v[72:75], v[4:7]
    s_waitcnt vmcnt(42)
    v_mfma_f32_16x16x32_bf16 v[8:11], v[84:87], v[72:75], v[8:11]
    s_waitcnt vmcnt(41)
    v_mfma_f32_16x16x32_bf16 v[12:15], v[100:103], v[72:75], v[12:15]
    buffer_load_dwordx4 v[72:75], v66, s[12:15], s82 offen offset:3072
    s_waitcnt vmcnt(41)
    v_mfma_f32_16x16x32_bf16 v[16:19], v[96:99], v[88:91], v[16:19]
    v_mfma_f32_16x16x32_bf16 v[20:23], v[80:83], v[88:91], v[20:23]
    v_mfma_f32_16x16x32_bf16 v[24:27], v[84:87], v[88:91], v[24:27]
    v_mfma_f32_16x16x32_bf16 v[28:31], v[100:103], v[88:91], v[28:31]
    buffer_load_dwordx4 v[88:91], v67, s[12:15], s82 offen offset:3072
    s_waitcnt vmcnt(41)
    v_mfma_f32_16x16x32_bf16 v[32:35], v[96:99], v[108:111], v[32:35]
    v_mfma_f32_16x16x32_bf16 v[36:39], v[80:83], v[108:111], v[36:39]
    v_mfma_f32_16x16x32_bf16 v[40:43], v[84:87], v[108:111], v[40:43]
    v_mfma_f32_16x16x32_bf16 v[44:47], v[100:103], v[108:111], v[44:47]
    buffer_load_dwordx4 v[108:111], v64, s[16:19], s87 offen offset:0
    s_waitcnt vmcnt(41)
    v_mfma_f32_16x16x32_bf16 v[48:51], v[96:99], v[124:127], v[48:51]
    buffer_load_dwordx4 v[96:99], v64, s[12:15], s83 offen offset:0
    v_mfma_f32_16x16x32_bf16 v[52:55], v[80:83], v[124:127], v[52:55]
    buffer_load_dwordx4 v[80:83], v65, s[16:19], s87 offen offset:0
    v_mfma_f32_16x16x32_bf16 v[56:59], v[84:87], v[124:127], v[56:59]
    buffer_load_dwordx4 v[84:87], v66, s[16:19], s87 offen offset:0
    v_mfma_f32_16x16x32_bf16 v[60:63], v[100:103], v[124:127], v[60:63]
    buffer_load_dwordx4 v[124:127], v67, s[16:19], s87 offen offset:0
    buffer_load_dwordx4 v[100:103], v65, s[12:15], s83 offen offset:0
    s_waitcnt vmcnt(44)
    v_mfma_f32_16x16x32_bf16 v[0:3], v[128:131], v[104:107], v[0:3]
    s_waitcnt vmcnt(43)
    v_mfma_f32_16x16x32_bf16 v[4:7], v[112:115], v[104:107], v[4:7]
    s_waitcnt vmcnt(42)
    v_mfma_f32_16x16x32_bf16 v[8:11], v[116:119], v[104:107], v[8:11]
    s_waitcnt vmcnt(41)
    v_mfma_f32_16x16x32_bf16 v[12:15], v[132:135], v[104:107], v[12:15]
    buffer_load_dwordx4 v[104:107], v66, s[12:15], s83 offen offset:0
    s_waitcnt vmcnt(41)
    v_mfma_f32_16x16x32_bf16 v[16:19], v[128:131], v[120:123], v[16:19]
    v_mfma_f32_16x16x32_bf16 v[20:23], v[112:115], v[120:123], v[20:23]
    v_mfma_f32_16x16x32_bf16 v[24:27], v[116:119], v[120:123], v[24:27]
    v_mfma_f32_16x16x32_bf16 v[28:31], v[132:135], v[120:123], v[28:31]
    buffer_load_dwordx4 v[120:123], v67, s[12:15], s83 offen offset:0
    s_waitcnt vmcnt(41)
    v_mfma_f32_16x16x32_bf16 v[32:35], v[128:131], v[140:143], v[32:35]
    v_mfma_f32_16x16x32_bf16 v[36:39], v[112:115], v[140:143], v[36:39]
    v_mfma_f32_16x16x32_bf16 v[40:43], v[116:119], v[140:143], v[40:43]
    v_mfma_f32_16x16x32_bf16 v[44:47], v[132:135], v[140:143], v[44:47]
    buffer_load_dwordx4 v[140:143], v64, s[16:19], s87 offen offset:1024
    s_waitcnt vmcnt(41)
    v_mfma_f32_16x16x32_bf16 v[48:51], v[128:131], v[156:159], v[48:51]
    buffer_load_dwordx4 v[128:131], v64, s[12:15], s83 offen offset:1024
    v_mfma_f32_16x16x32_bf16 v[52:55], v[112:115], v[156:159], v[52:55]
    buffer_load_dwordx4 v[112:115], v65, s[16:19], s87 offen offset:1024
    v_mfma_f32_16x16x32_bf16 v[56:59], v[116:119], v[156:159], v[56:59]
    buffer_load_dwordx4 v[116:119], v66, s[16:19], s87 offen offset:1024
    v_mfma_f32_16x16x32_bf16 v[60:63], v[132:135], v[156:159], v[60:63]
    buffer_load_dwordx4 v[156:159], v67, s[16:19], s87 offen offset:1024
    buffer_load_dwordx4 v[132:135], v65, s[12:15], s83 offen offset:1024
    s_waitcnt vmcnt(44)
    v_mfma_f32_16x16x32_bf16 v[0:3], v[160:163], v[136:139], v[0:3]
    s_waitcnt vmcnt(43)
    v_mfma_f32_16x16x32_bf16 v[4:7], v[144:147], v[136:139], v[4:7]
    s_waitcnt vmcnt(42)
    v_mfma_f32_16x16x32_bf16 v[8:11], v[148:151], v[136:139], v[8:11]
    s_waitcnt vmcnt(41)
    v_mfma_f32_16x16x32_bf16 v[12:15], v[164:167], v[136:139], v[12:15]
    buffer_load_dwordx4 v[136:139], v66, s[12:15], s83 offen offset:1024
    s_waitcnt vmcnt(41)
    v_mfma_f32_16x16x32_bf16 v[16:19], v[160:163], v[152:155], v[16:19]
    v_mfma_f32_16x16x32_bf16 v[20:23], v[144:147], v[152:155], v[20:23]
    v_mfma_f32_16x16x32_bf16 v[24:27], v[148:151], v[152:155], v[24:27]
    v_mfma_f32_16x16x32_bf16 v[28:31], v[164:167], v[152:155], v[28:31]
    buffer_load_dwordx4 v[152:155], v67, s[12:15], s83 offen offset:1024
    s_waitcnt vmcnt(41)
    v_mfma_f32_16x16x32_bf16 v[32:35], v[160:163], v[172:175], v[32:35]
    v_mfma_f32_16x16x32_bf16 v[36:39], v[144:147], v[172:175], v[36:39]
    v_mfma_f32_16x16x32_bf16 v[40:43], v[148:151], v[172:175], v[40:43]
    v_mfma_f32_16x16x32_bf16 v[44:47], v[164:167], v[172:175], v[44:47]
    s_waitcnt vmcnt(40)
    v_mfma_f32_16x16x32_bf16 v[48:51], v[160:163], v[188:191], v[48:51]
    v_mfma_f32_16x16x32_bf16 v[52:55], v[144:147], v[188:191], v[52:55]
    v_mfma_f32_16x16x32_bf16 v[56:59], v[148:151], v[188:191], v[56:59]
    v_mfma_f32_16x16x32_bf16 v[60:63], v[164:167], v[188:191], v[60:63]
    s_waitcnt vmcnt(38)
    v_mfma_f32_16x16x32_bf16 v[0:3], v[192:195], v[168:171], v[0:3]
    s_waitcnt vmcnt(37)
    v_mfma_f32_16x16x32_bf16 v[4:7], v[176:179], v[168:171], v[4:7]
    s_waitcnt vmcnt(36)
    v_mfma_f32_16x16x32_bf16 v[8:11], v[180:183], v[168:171], v[8:11]
    s_waitcnt vmcnt(35)
    v_mfma_f32_16x16x32_bf16 v[12:15], v[196:199], v[168:171], v[12:15]
    s_waitcnt vmcnt(34)
    v_mfma_f32_16x16x32_bf16 v[16:19], v[192:195], v[184:187], v[16:19]
    v_mfma_f32_16x16x32_bf16 v[20:23], v[176:179], v[184:187], v[20:23]
    v_mfma_f32_16x16x32_bf16 v[24:27], v[180:183], v[184:187], v[24:27]
    v_mfma_f32_16x16x32_bf16 v[28:31], v[196:199], v[184:187], v[28:31]
    s_waitcnt vmcnt(33)
    v_mfma_f32_16x16x32_bf16 v[32:35], v[192:195], v[204:207], v[32:35]
    v_mfma_f32_16x16x32_bf16 v[36:39], v[176:179], v[204:207], v[36:39]
    v_mfma_f32_16x16x32_bf16 v[40:43], v[180:183], v[204:207], v[40:43]
    v_mfma_f32_16x16x32_bf16 v[44:47], v[196:199], v[204:207], v[44:47]
    s_waitcnt vmcnt(32)
    v_mfma_f32_16x16x32_bf16 v[48:51], v[192:195], v[220:223], v[48:51]
    v_mfma_f32_16x16x32_bf16 v[52:55], v[176:179], v[220:223], v[52:55]
    v_mfma_f32_16x16x32_bf16 v[56:59], v[180:183], v[220:223], v[56:59]
    v_mfma_f32_16x16x32_bf16 v[60:63], v[196:199], v[220:223], v[60:63]
    s_waitcnt vmcnt(30)
    v_mfma_f32_16x16x32_bf16 v[0:3], v[224:227], v[200:203], v[0:3]
    s_waitcnt vmcnt(29)
    v_mfma_f32_16x16x32_bf16 v[4:7], v[208:211], v[200:203], v[4:7]
    s_waitcnt vmcnt(28)
    v_mfma_f32_16x16x32_bf16 v[8:11], v[212:215], v[200:203], v[8:11]
    s_waitcnt vmcnt(27)
    v_mfma_f32_16x16x32_bf16 v[12:15], v[228:231], v[200:203], v[12:15]
    s_waitcnt vmcnt(26)
    v_mfma_f32_16x16x32_bf16 v[16:19], v[224:227], v[216:219], v[16:19]
    v_mfma_f32_16x16x32_bf16 v[20:23], v[208:211], v[216:219], v[20:23]
    v_mfma_f32_16x16x32_bf16 v[24:27], v[212:215], v[216:219], v[24:27]
    v_mfma_f32_16x16x32_bf16 v[28:31], v[228:231], v[216:219], v[28:31]
    s_waitcnt vmcnt(25)
    v_mfma_f32_16x16x32_bf16 v[32:35], v[224:227], v[236:239], v[32:35]
    v_mfma_f32_16x16x32_bf16 v[36:39], v[208:211], v[236:239], v[36:39]
    v_mfma_f32_16x16x32_bf16 v[40:43], v[212:215], v[236:239], v[40:43]
    v_mfma_f32_16x16x32_bf16 v[44:47], v[228:231], v[236:239], v[44:47]
    s_waitcnt vmcnt(24)
    v_mfma_f32_16x16x32_bf16 v[48:51], v[224:227], v[252:255], v[48:51]
    v_mfma_f32_16x16x32_bf16 v[52:55], v[208:211], v[252:255], v[52:55]
    v_mfma_f32_16x16x32_bf16 v[56:59], v[212:215], v[252:255], v[56:59]
    v_mfma_f32_16x16x32_bf16 v[60:63], v[228:231], v[252:255], v[60:63]
    s_waitcnt vmcnt(22)
    v_mfma_f32_16x16x32_bf16 v[0:3], v[76:79], v[232:235], v[0:3]
    s_waitcnt vmcnt(21)
    v_mfma_f32_16x16x32_bf16 v[4:7], v[240:243], v[232:235], v[4:7]
    s_waitcnt vmcnt(20)
    v_mfma_f32_16x16x32_bf16 v[8:11], v[244:247], v[232:235], v[8:11]
    s_waitcnt vmcnt(19)
    v_mfma_f32_16x16x32_bf16 v[12:15], v[92:95], v[232:235], v[12:15]
    s_waitcnt vmcnt(18)
    v_mfma_f32_16x16x32_bf16 v[16:19], v[76:79], v[248:251], v[16:19]
    v_mfma_f32_16x16x32_bf16 v[20:23], v[240:243], v[248:251], v[20:23]
    v_mfma_f32_16x16x32_bf16 v[24:27], v[244:247], v[248:251], v[24:27]
    v_mfma_f32_16x16x32_bf16 v[28:31], v[92:95], v[248:251], v[28:31]
    s_waitcnt vmcnt(17)
    v_mfma_f32_16x16x32_bf16 v[32:35], v[76:79], v[72:75], v[32:35]
    v_mfma_f32_16x16x32_bf16 v[36:39], v[240:243], v[72:75], v[36:39]
    v_mfma_f32_16x16x32_bf16 v[40:43], v[244:247], v[72:75], v[40:43]
    v_mfma_f32_16x16x32_bf16 v[44:47], v[92:95], v[72:75], v[44:47]
    s_waitcnt vmcnt(16)
    v_mfma_f32_16x16x32_bf16 v[48:51], v[76:79], v[88:91], v[48:51]
    v_mfma_f32_16x16x32_bf16 v[52:55], v[240:243], v[88:91], v[52:55]
    v_mfma_f32_16x16x32_bf16 v[56:59], v[244:247], v[88:91], v[56:59]
    v_mfma_f32_16x16x32_bf16 v[60:63], v[92:95], v[88:91], v[60:63]
    s_waitcnt vmcnt(14)
    v_mfma_f32_16x16x32_bf16 v[0:3], v[108:111], v[96:99], v[0:3]
    s_waitcnt vmcnt(13)
    v_mfma_f32_16x16x32_bf16 v[4:7], v[80:83], v[96:99], v[4:7]
    s_waitcnt vmcnt(12)
    v_mfma_f32_16x16x32_bf16 v[8:11], v[84:87], v[96:99], v[8:11]
    s_waitcnt vmcnt(11)
    v_mfma_f32_16x16x32_bf16 v[12:15], v[124:127], v[96:99], v[12:15]
    s_waitcnt vmcnt(10)
    v_mfma_f32_16x16x32_bf16 v[16:19], v[108:111], v[100:103], v[16:19]
    v_mfma_f32_16x16x32_bf16 v[20:23], v[80:83], v[100:103], v[20:23]
    v_mfma_f32_16x16x32_bf16 v[24:27], v[84:87], v[100:103], v[24:27]
    v_mfma_f32_16x16x32_bf16 v[28:31], v[124:127], v[100:103], v[28:31]
    s_waitcnt vmcnt(9)
    v_mfma_f32_16x16x32_bf16 v[32:35], v[108:111], v[104:107], v[32:35]
    v_mfma_f32_16x16x32_bf16 v[36:39], v[80:83], v[104:107], v[36:39]
    v_mfma_f32_16x16x32_bf16 v[40:43], v[84:87], v[104:107], v[40:43]
    v_mfma_f32_16x16x32_bf16 v[44:47], v[124:127], v[104:107], v[44:47]
    s_waitcnt vmcnt(8)
    v_mfma_f32_16x16x32_bf16 v[48:51], v[108:111], v[120:123], v[48:51]
    v_mfma_f32_16x16x32_bf16 v[52:55], v[80:83], v[120:123], v[52:55]
    v_mfma_f32_16x16x32_bf16 v[56:59], v[84:87], v[120:123], v[56:59]
    v_mfma_f32_16x16x32_bf16 v[60:63], v[124:127], v[120:123], v[60:63]
    s_waitcnt vmcnt(6)
    v_mfma_f32_16x16x32_bf16 v[0:3], v[140:143], v[128:131], v[0:3]
    s_waitcnt vmcnt(5)
    v_mfma_f32_16x16x32_bf16 v[4:7], v[112:115], v[128:131], v[4:7]
    s_waitcnt vmcnt(4)
    v_mfma_f32_16x16x32_bf16 v[8:11], v[116:119], v[128:131], v[8:11]
    s_waitcnt vmcnt(3)
    v_mfma_f32_16x16x32_bf16 v[12:15], v[156:159], v[128:131], v[12:15]
    s_waitcnt vmcnt(2)
    v_mfma_f32_16x16x32_bf16 v[16:19], v[140:143], v[132:135], v[16:19]
    v_mfma_f32_16x16x32_bf16 v[20:23], v[112:115], v[132:135], v[20:23]
    v_mfma_f32_16x16x32_bf16 v[24:27], v[116:119], v[132:135], v[24:27]
    v_mfma_f32_16x16x32_bf16 v[28:31], v[156:159], v[132:135], v[28:31]
    s_waitcnt vmcnt(1)
    v_mfma_f32_16x16x32_bf16 v[32:35], v[140:143], v[136:139], v[32:35]
    v_mfma_f32_16x16x32_bf16 v[36:39], v[112:115], v[136:139], v[36:39]
    v_mfma_f32_16x16x32_bf16 v[40:43], v[116:119], v[136:139], v[40:43]
    v_mfma_f32_16x16x32_bf16 v[44:47], v[156:159], v[136:139], v[44:47]
    s_waitcnt vmcnt(0)
    v_mfma_f32_16x16x32_bf16 v[48:51], v[140:143], v[152:155], v[48:51]
    v_mfma_f32_16x16x32_bf16 v[52:55], v[112:115], v[152:155], v[52:55]
    v_mfma_f32_16x16x32_bf16 v[56:59], v[116:119], v[152:155], v[56:59]
    v_mfma_f32_16x16x32_bf16 v[60:63], v[156:159], v[152:155], v[60:63]
    s_nop 7
    s_nop 7
    s_nop 7
    s_cmp_eq_u32 s54, 0
    s_cbranch_scc1 L_g2d_sk0
    s_cmp_gt_u32 s54, 0
    s_cselect_b32 s55, 1, 0
    s_sub_u32 s55, s54, s55
    s_add_u32 s55, s55, 0
    s_lshl_b32 s55, s55, 12
    v_add_u32 v69, s55, v71
    ds_write_b128 v69, v[0:3] offset:0
    ds_write_b128 v69, v[4:7] offset:1024
    ds_write_b128 v69, v[8:11] offset:2048
    ds_write_b128 v69, v[12:15] offset:3072
L_g2d_sk0:
    s_cmp_eq_u32 s54, 1
    s_cbranch_scc1 L_g2d_sk1
    s_cmp_gt_u32 s54, 1
    s_cselect_b32 s55, 1, 0
    s_sub_u32 s55, s54, s55
    s_add_u32 s55, s55, 3
    s_lshl_b32 s55, s55, 12
    v_add_u32 v69, s55, v71
    ds_write_b128 v69, v[16:19] offset:0
    ds_write_b128 v69, v[20:23] offset:1024
    ds_write_b128 v69, v[24:27] offset:2048
    ds_write_b128 v69, v[28:31] offset:3072
L_g2d_sk1:
    s_cmp_eq_u32 s54, 2
    s_cbranch_scc1 L_g2d_sk2
    s_cmp_gt_u32 s54, 2
    s_cselect_b32 s55, 1, 0
    s_sub_u32 s55, s54, s55
    s_add_u32 s55, s55, 6
    s_lshl_b32 s55, s55, 12
    v_add_u32 v69, s55, v71
    ds_write_b128 v69, v[32:35] offset:0
    ds_write_b128 v69, v[36:39] offset:1024
    ds_write_b128 v69, v[40:43] offset:2048
    ds_write_b128 v69, v[44:47] offset:3072
L_g2d_sk2:
    s_cmp_eq_u32 s54, 3
    s_cbranch_scc1 L_g2d_sk3
    s_cmp_gt_u32 s54, 3
    s_cselect_b32 s55, 1, 0
    s_sub_u32 s55, s54, s55
    s_add_u32 s55, s55, 9
    s_lshl_b32 s55, s55, 12
    v_add_u32 v69, s55, v71
    ds_write_b128 v69, v[48:51] offset:0
    ds_write_b128 v69, v[52:55] offset:1024
    ds_write_b128 v69, v[56:59] offset:2048
    ds_write_b128 v69, v[60:63] offset:3072
L_g2d_sk3:
    s_mul_i32 s55, s54, 0x3000
    v_add_u32 v69, s55, v71
    s_lshl_b32 s52, s46, 16
    s_lshl_b32 s53, s47, 7
    s_add_u32 s52, s52, s53
    s_mov_b32 s60, 0xbfb8aa3b
    s_mov_b32 s61, 0xbfb8aa3b
    s_mov_b32 s62, 1.0
    s_mov_b32 s63, 1.0
    s_waitcnt lgkmcnt(0)
    s_barrier
    ds_read_b128 v[72:75], v69 offset:0
    ds_read_b128 v[76:79], v69 offset:1024
    ds_read_b128 v[80:83], v69 offset:2048
    ds_read_b128 v[84:87], v69 offset:3072
    ds_read_b128 v[88:91], v69 offset:4096
    ds_read_b128 v[92:95], v69 offset:5120
    ds_read_b128 v[96:99], v69 offset:6144
    ds_read_b128 v[100:103], v69 offset:7168
    ds_read_b128 v[104:107], v69 offset:8192
    ds_read_b128 v[108:111], v69 offset:9216
    ds_read_b128 v[112:115], v69 offset:10240
    ds_read_b128 v[116:119], v69 offset:11264
    s_cmp_lg_u32 s54, 0
    s_cbranch_scc1 L_g2d_e0
    s_waitcnt lgkmcnt(8)
    v_pk_add_f32 v[0:1], v[0:1], v[72:73]
    v_pk_add_f32 v[2:3], v[2:3], v[74:75]
    v_pk_add_f32 v[4:5], v[4:5], v[76:77]
    v_pk_add_f32 v[6:7], v[6:7], v[78:79]
    v_pk_add_f32 v[8:9], v[8:9], v[80:81]
    v_pk_add_f32 v[10:11], v[10:11], v[82:83]
    v_pk_add_f32 v[12:13], v[12:13], v[84:85]
    v_pk_add_f32 v[14:15], v[14:15], v[86:87]
    s_waitcnt lgkmcnt(4)
    v_pk_add_f32 v[0:1], v[0:1], v[88:89]
    v_pk_add_f32 v[2:3], v[2:3], v[90:91]
    v_pk_add_f32 v[4:5], v[4:5], v[92:93]
    v_pk_add_f32 v[6:7], v[6:7], v[94:95]
    v_pk_add_f32 v[8:9], v[8:9], v[96:97]
    v_pk_add_f32 v[10:11], v[10:11], v[98:99]
    v_pk_add_f32 v[12:13], v[12:13], v[100:101]
    v_pk_add_f32 v[14:15], v[14:15], v[102:103]
    s_waitcnt lgkmcnt(0)
    v_pk_add_f32 v[0:1], v[0:1], v[104:105]
    v_pk_add_f32 v[2:3], v[2:3], v[106:107]
    v_pk_add_f32 v[4:5], v[4:5], v[108:109]
    v_pk_add_f32 v[6:7], v[6:7], v[110:111]
    v_pk_add_f32 v[8:9], v[8:9], v[112:113]
    v_pk_add_f32 v[10:11], v[10:11], v[114:115]
    v_pk_add_f32 v[12:13], v[12:13], v[116:117]
    v_pk_add_f32 v[14:15], v[14:15], v[118:119]
    v_cvt_pk_bf16_f32 v128, v0, v1
    v_cvt_pk_bf16_f32 v130, v2, v3
    v_cvt_pk_bf16_f32 v132, v4, v5
    v_cvt_pk_bf16_f32 v134, v6, v7
    v_cvt_pk_bf16_f32 v136, v8, v9
    v_cvt_pk_bf16_f32 v138, v10, v11
    v_cvt_pk_bf16_f32 v140, v12, v13
    v_cvt_pk_bf16_f32 v142, v14, v15
    v_lshlrev_b32 v0, 16, v128
    v_and_b32 v1, 0xffff0000, v128
    v_lshlrev_b32 v2, 16, v130
    v_and_b32 v3, 0xffff0000, v130
    v_lshlrev_b32 v4, 16, v132
    v_and_b32 v5, 0xffff0000, v132
    v_lshlrev_b32 v6, 16, v134
    v_and_b32 v7, 0xffff0000, v134
    v_lshlrev_b32 v8, 16, v136
    v_and_b32 v9, 0xffff0000, v136
    v_lshlrev_b32 v10, 16, v138
    v_and_b32 v11, 0xffff0000, v138
    v_lshlrev_b32 v12, 16, v140
    v_and_b32 v13, 0xffff0000, v140
    v_lshlrev_b32 v14, 16, v142
    v_and_b32 v15, 0xffff0000, v142
    v_pk_mul_f32 v[128:129], v[0:1], s[60:61]
    v_pk_mul_f32 v[130:131], v[2:3], s[60:61]
    v_pk_mul_f32 v[132:133], v[4:5], s[60:61]
    v_pk_mul_f32 v[134:135], v[6:7], s[60:61]
    v_pk_mul_f32 v[136:137], v[8:9], s[60:61]
    v_pk_mul_f32 v[138:139], v[10:11], s[60:61]
    v_pk_mul_f32 v[140:141], v[12:13], s[60:61]
    v_pk_mul_f32 v[142:143], v[14:15], s[60:61]
    v_exp_f32 v128, v128
    v_exp_f32 v129, v129
    v_exp_f32 v130, v130
    v_exp_f32 v131, v131
    v_exp_f32 v132, v132
    v_exp_f32 v133, v133
    v_exp_f32 v134, v134
    v_exp_f32 v135, v135
    v_exp_f32 v136, v136
    v_exp_f32 v137, v137
    v_exp_f32 v138, v138
    v_exp_f32 v139, v139
    v_exp_f32 v140, v140
    v_exp_f32 v141, v141
    v_exp_f32 v142, v142
    v_exp_f32 v143, v143
    v_pk_add_f32 v[128:129], v[128:129], s[62:63]
    v_pk_add_f32 v[130:131], v[130:131], s[62:63]
    v_pk_add_f32 v[132:133], v[132:133], s[62:63]
    v_pk_add_f32 v[134:135], v[134:135], s[62:63]
    v_pk_add_f32 v[136:137], v[136:137], s[62:63]
    v_pk_add_f32 v[138:139], v[138:139], s[62:63]
    v_pk_add_f32 v[140:141], v[140:141], s[62:63]
    v_pk_add_f32 v[142:143], v[142:143], s[62:63]
    v_rcp_f32 v128, v128
    v_rcp_f32 v129, v129
    v_rcp_f32 v130, v130
    v_rcp_f32 v131, v131
    v_rcp_f32 v132, v132
    v_rcp_f32 v133, v133
    v_rcp_f32 v134, v134
    v_rcp_f32 v135, v135
    v_rcp_f32 v136, v136
    v_rcp_f32 v137, v137
    v_rcp_f32 v138, v138
    v_rcp_f32 v139, v139
    v_rcp_f32 v140, v140
    v_rcp_f32 v141, v141
    v_rcp_f32 v142, v142
    v_rcp_f32 v143, v143
    v_pk_mul_f32 v[0:1], v[0:1], v[128:129]
    v_pk_mul_f32 v[2:3], v[2:3], v[130:131]
    v_pk_mul_f32 v[4:5], v[4:5], v[132:133]
    v_pk_mul_f32 v[6:7], v[6:7], v[134:135]
    v_pk_mul_f32 v[8:9], v[8:9], v[136:137]
    v_pk_mul_f32 v[10:11], v[10:11], v[138:139]
    v_pk_mul_f32 v[12:13], v[12:13], v[140:141]
    v_pk_mul_f32 v[14:15], v[14:15], v[142:143]
    v_cvt_pk_bf16_f32 v0, v0, v1
    v_cvt_pk_bf16_f32 v1, v2, v3
    v_cvt_pk_bf16_f32 v4, v4, v5
    v_cvt_pk_bf16_f32 v5, v6, v7
    v_cvt_pk_bf16_f32 v8, v8, v9
    v_cvt_pk_bf16_f32 v9, v10, v11
    v_cvt_pk_bf16_f32 v12, v12, v13
    v_cvt_pk_bf16_f32 v13, v14, v15
    buffer_store_dwordx2 v[0:1], v70, s[24:27], s52 offen offset:0
    buffer_store_dwordx2 v[4:5], v70, s[24:27], s52 offen offset:32
    buffer_store_dwordx2 v[8:9], v70, s[24:27], s52 offen offset:64
    buffer_store_dwordx2 v[12:13], v70, s[24:27], s52 offen offset:96
    s_waitcnt lgkmcnt(0)
    s_endpgm
L_g2d_e0:
    s_cmp_lg_u32 s54, 1
    s_cbranch_scc1 L_g2d_e1
    s_waitcnt lgkmcnt(8)
    v_pk_add_f32 v[16:17], v[16:17], v[72:73]
    v_pk_add_f32 v[18:19], v[18:19], v[74:75]
    v_pk_add_f32 v[20:21], v[20:21], v[76:77]
    v_pk_add_f32 v[22:23], v[22:23], v[78:79]
    v_pk_add_f32 v[24:25], v[24:25], v[80:81]
    v_pk_add_f32 v[26:27], v[26:27], v[82:83]
    v_pk_add_f32 v[28:29], v[28:29], v[84:85]
    v_pk_add_f32 v[30:31], v[30:31], v[86:87]
    s_waitcnt lgkmcnt(4)
    v_pk_add_f32 v[16:17], v[16:17], v[88:89]
    v_pk_add_f32 v[18:19], v[18:19], v[90:91]
    v_pk_add_f32 v[20:21], v[20:21], v[92:93]
    v_pk_add_f32 v[22:23], v[22:23], v[94:95]
    v_pk_add_f32 v[24:25], v[24:25], v[96:97]
    v_pk_add_f32 v[26:27], v[26:27], v[98:99]
    v_pk_add_f32 v[28:29], v[28:29], v[100:101]
    v_pk_add_f32 v[30:31], v[30:31], v[102:103]
    s_waitcnt lgkmcnt(0)
    v_pk_add_f32 v[16:17], v[16:17], v[104:105]
    v_pk_add_f32 v[18:19], v[18:19], v[106:107]
    v_pk_add_f32 v[20:21], v[20:21], v[108:109]
    v_pk_add_f32 v[22:23], v[22:23], v[110:111]
    v_pk_add_f32 v[24:25], v[24:25], v[112:113]
    v_pk_add_f32 v[26:27], v[26:27], v[114:115]
    v_pk_add_f32 v[28:29], v[28:29], v[116:117]
    v_pk_add_f32 v[30:31], v[30:31], v[118:119]
    v_cvt_pk_bf16_f32 v128, v16, v17
    v_cvt_pk_bf16_f32 v130, v18, v19
    v_cvt_pk_bf16_f32 v132, v20, v21
    v_cvt_pk_bf16_f32 v134, v22, v23
    v_cvt_pk_bf16_f32 v136, v24, v25
    v_cvt_pk_bf16_f32 v138, v26, v27
    v_cvt_pk_bf16_f32 v140, v28, v29
    v_cvt_pk_bf16_f32 v142, v30, v31
    v_lshlrev_b32 v16, 16, v128
    v_and_b32 v17, 0xffff0000, v128
    v_lshlrev_b32 v18, 16, v130
    v_and_b32 v19, 0xffff0000, v130
    v_lshlrev_b32 v20, 16, v132
    v_and_b32 v21, 0xffff0000, v132
    v_lshlrev_b32 v22, 16, v134
    v_and_b32 v23, 0xffff0000, v134
    v_lshlrev_b32 v24, 16, v136
    v_and_b32 v25, 0xffff0000, v136
    v_lshlrev_b32 v26, 16, v138
    v_and_b32 v27, 0xffff0000, v138
    v_lshlrev_b32 v28, 16, v140
    v_and_b32 v29, 0xffff0000, v140
    v_lshlrev_b32 v30, 16, v142
    v_and_b32 v31, 0xffff0000, v142
    v_pk_mul_f32 v[128:129], v[16:17], s[60:61]
    v_pk_mul_f32 v[130:131], v[18:19], s[60:61]
    v_pk_mul_f32 v[132:133], v[20:21], s[60:61]
    v_pk_mul_f32 v[134:135], v[22:23], s[60:61]
    v_pk_mul_f32 v[136:137], v[24:25], s[60:61]
    v_pk_mul_f32 v[138:139], v[26:27], s[60:61]
    v_pk_mul_f32 v[140:141], v[28:29], s[60:61]
    v_pk_mul_f32 v[142:143], v[30:31], s[60:61]
    v_exp_f32 v128, v128
    v_exp_f32 v129, v129
    v_exp_f32 v130, v130
    v_exp_f32 v131, v131
    v_exp_f32 v132, v132
    v_exp_f32 v133, v133
    v_exp_f32 v134, v134
    v_exp_f32 v135, v135
    v_exp_f32 v136, v136
    v_exp_f32 v137, v137
    v_exp_f32 v138, v138
    v_exp_f32 v139, v139
    v_exp_f32 v140, v140
    v_exp_f32 v141, v141
    v_exp_f32 v142, v142
    v_exp_f32 v143, v143
    v_pk_add_f32 v[128:129], v[128:129], s[62:63]
    v_pk_add_f32 v[130:131], v[130:131], s[62:63]
    v_pk_add_f32 v[132:133], v[132:133], s[62:63]
    v_pk_add_f32 v[134:135], v[134:135], s[62:63]
    v_pk_add_f32 v[136:137], v[136:137], s[62:63]
    v_pk_add_f32 v[138:139], v[138:139], s[62:63]
    v_pk_add_f32 v[140:141], v[140:141], s[62:63]
    v_pk_add_f32 v[142:143], v[142:143], s[62:63]
    v_rcp_f32 v128, v128
    v_rcp_f32 v129, v129
    v_rcp_f32 v130, v130
    v_rcp_f32 v131, v131
    v_rcp_f32 v132, v132
    v_rcp_f32 v133, v133
    v_rcp_f32 v134, v134
    v_rcp_f32 v135, v135
    v_rcp_f32 v136, v136
    v_rcp_f32 v137, v137
    v_rcp_f32 v138, v138
    v_rcp_f32 v139, v139
    v_rcp_f32 v140, v140
    v_rcp_f32 v141, v141
    v_rcp_f32 v142, v142
    v_rcp_f32 v143, v143
    v_pk_mul_f32 v[16:17], v[16:17], v[128:129]
    v_pk_mul_f32 v[18:19], v[18:19], v[130:131]
    v_pk_mul_f32 v[20:21], v[20:21], v[132:133]
    v_pk_mul_f32 v[22:23], v[22:23], v[134:135]
    v_pk_mul_f32 v[24:25], v[24:25], v[136:137]
    v_pk_mul_f32 v[26:27], v[26:27], v[138:139]
    v_pk_mul_f32 v[28:29], v[28:29], v[140:141]
    v_pk_mul_f32 v[30:31], v[30:31], v[142:143]
    v_cvt_pk_bf16_f32 v16, v16, v17
    v_cvt_pk_bf16_f32 v17, v18, v19
    v_cvt_pk_bf16_f32 v20, v20, v21
    v_cvt_pk_bf16_f32 v21, v22, v23
    v_cvt_pk_bf16_f32 v24, v24, v25
    v_cvt_pk_bf16_f32 v25, v26, v27
    v_cvt_pk_bf16_f32 v28, v28, v29
    v_cvt_pk_bf16_f32 v29, v30, v31
    buffer_store_dwordx2 v[16:17], v70, s[24:27], s52 offen offset:0
    buffer_store_dwordx2 v[20:21], v70, s[24:27], s52 offen offset:32
    buffer_store_dwordx2 v[24:25], v70, s[24:27], s52 offen offset:64
    buffer_store_dwordx2 v[28:29], v70, s[24:27], s52 offen offset:96
    s_waitcnt lgkmcnt(0)
    s_endpgm
L_g2d_e1:
    s_cmp_lg_u32 s54, 2
    s_cbranch_scc1 L_g2d_e2
    s_waitcnt lgkmcnt(8)
    v_pk_add_f32 v[32:33], v[32:33], v[72:73]
    v_pk_add_f32 v[34:35], v[34:35], v[74:75]
    v_pk_add_f32 v[36:37], v[36:37], v[76:77]
    v_pk_add_f32 v[38:39], v[38:39], v[78:79]
    v_pk_add_f32 v[40:41], v[40:41], v[80:81]
    v_pk_add_f32 v[42:43], v[42:43], v[82:83]
    v_pk_add_f32 v[44:45], v[44:45], v[84:85]
    v_pk_add_f32 v[46:47], v[46:47], v[86:87]
    s_waitcnt lgkmcnt(4)
    v_pk_add_f32 v[32:33], v[32:33], v[88:89]
    v_pk_add_f32 v[34:35], v[34:35], v[90:91]
    v_pk_add_f32 v[36:37], v[36:37], v[92:93]
    v_pk_add_f32 v[38:39], v[38:39], v[94:95]
    v_pk_add_f32 v[40:41], v[40:41], v[96:97]
    v_pk_add_f32 v[42:43], v[42:43], v[98:99]
    v_pk_add_f32 v[44:45], v[44:45], v[100:101]
    v_pk_add_f32 v[46:47], v[46:47], v[102:103]
    s_waitcnt lgkmcnt(0)
    v_pk_add_f32 v[32:33], v[32:33], v[104:105]
    v_pk_add_f32 v[34:35], v[34:35], v[106:107]
    v_pk_add_f32 v[36:37], v[36:37], v[108:109]
    v_pk_add_f32 v[38:39], v[38:39], v[110:111]
    v_pk_add_f32 v[40:41], v[40:41], v[112:113]
    v_pk_add_f32 v[42:43], v[42:43], v[114:115]
    v_pk_add_f32 v[44:45], v[44:45], v[116:117]
    v_pk_add_f32 v[46:47], v[46:47], v[118:119]
    v_cvt_pk_bf16_f32 v128, v32, v33
    v_cvt_pk_bf16_f32 v130, v34, v35
    v_cvt_pk_bf16_f32 v132, v36, v37
    v_cvt_pk_bf16_f32 v134, v38, v39
    v_cvt_pk_bf16_f32 v136, v40, v41
    v_cvt_pk_bf16_f32 v138, v42, v43
    v_cvt_pk_bf16_f32 v140, v44, v45
    v_cvt_pk_bf16_f32 v142, v46, v47
    v_lshlrev_b32 v32, 16, v128
    v_and_b32 v33, 0xffff0000, v128
    v_lshlrev_b32 v34, 16, v130
    v_and_b32 v35, 0xffff0000, v130
    v_lshlrev_b32 v36, 16, v132
    v_and_b32 v37, 0xffff0000, v132
    v_lshlrev_b32 v38, 16, v134
    v_and_b32 v39, 0xffff0000, v134
    v_lshlrev_b32 v40, 16, v136
    v_and_b32 v41, 0xffff0000, v136
    v_lshlrev_b32 v42, 16, v138
    v_and_b32 v43, 0xffff0000, v138
    v_lshlrev_b32 v44, 16, v140
    v_and_b32 v45, 0xffff0000, v140
    v_lshlrev_b32 v46, 16, v142
    v_and_b32 v47, 0xffff0000, v142
    v_pk_mul_f32 v[128:129], v[32:33], s[60:61]
    v_pk_mul_f32 v[130:131], v[34:35], s[60:61]
    v_pk_mul_f32 v[132:133], v[36:37], s[60:61]
    v_pk_mul_f32 v[134:135], v[38:39], s[60:61]
    v_pk_mul_f32 v[136:137], v[40:41], s[60:61]
    v_pk_mul_f32 v[138:139], v[42:43], s[60:61]
    v_pk_mul_f32 v[140:141], v[44:45], s[60:61]
    v_pk_mul_f32 v[142:143], v[46:47], s[60:61]
    v_exp_f32 v128, v128
    v_exp_f32 v129, v129
    v_exp_f32 v130, v130
    v_exp_f32 v131, v131
    v_exp_f32 v132, v132
    v_exp_f32 v133, v133
    v_exp_f32 v134, v134
    v_exp_f32 v135, v135
    v_exp_f32 v136, v136
    v_exp_f32 v137, v137
    v_exp_f32 v138, v138
    v_exp_f32 v139, v139
    v_exp_f32 v140, v140
    v_exp_f32 v141, v141
    v_exp_f32 v142, v142
    v_exp_f32 v143, v143
    v_pk_add_f32 v[128:129], v[128:129], s[62:63]
    v_pk_add_f32 v[130:131], v[130:131], s[62:63]
    v_pk_add_f32 v[132:133], v[132:133], s[62:63]
    v_pk_add_f32 v[134:135], v[134:135], s[62:63]
    v_pk_add_f32 v[136:137], v[136:137], s[62:63]
    v_pk_add_f32 v[138:139], v[138:139], s[62:63]
    v_pk_add_f32 v[140:141], v[140:141], s[62:63]
    v_pk_add_f32 v[142:143], v[142:143], s[62:63]
    v_rcp_f32 v128, v128
    v_rcp_f32 v129, v129
    v_rcp_f32 v130, v130
    v_rcp_f32 v131, v131
    v_rcp_f32 v132, v132
    v_rcp_f32 v133, v133
    v_rcp_f32 v134, v134
    v_rcp_f32 v135, v135
    v_rcp_f32 v136, v136
    v_rcp_f32 v137, v137
    v_rcp_f32 v138, v138
    v_rcp_f32 v139, v139
    v_rcp_f32 v140, v140
    v_rcp_f32 v141, v141
    v_rcp_f32 v142, v142
    v_rcp_f32 v143, v143
    v_pk_mul_f32 v[32:33], v[32:33], v[128:129]
    v_pk_mul_f32 v[34:35], v[34:35], v[130:131]
    v_pk_mul_f32 v[36:37], v[36:37], v[132:133]
    v_pk_mul_f32 v[38:39], v[38:39], v[134:135]
    v_pk_mul_f32 v[40:41], v[40:41], v[136:137]
    v_pk_mul_f32 v[42:43], v[42:43], v[138:139]
    v_pk_mul_f32 v[44:45], v[44:45], v[140:141]
    v_pk_mul_f32 v[46:47], v[46:47], v[142:143]
    v_cvt_pk_bf16_f32 v32, v32, v33
    v_cvt_pk_bf16_f32 v33, v34, v35
    v_cvt_pk_bf16_f32 v36, v36, v37
    v_cvt_pk_bf16_f32 v37, v38, v39
    v_cvt_pk_bf16_f32 v40, v40, v41
    v_cvt_pk_bf16_f32 v41, v42, v43
    v_cvt_pk_bf16_f32 v44, v44, v45
    v_cvt_pk_bf16_f32 v45, v46, v47
    buffer_store_dwordx2 v[32:33], v70, s[24:27], s52 offen offset:0
    buffer_store_dwordx2 v[36:37], v70, s[24:27], s52 offen offset:32
    buffer_store_dwordx2 v[40:41], v70, s[24:27], s52 offen offset:64
    buffer_store_dwordx2 v[44:45], v70, s[24:27], s52 offen offset:96
    s_waitcnt lgkmcnt(0)
    s_endpgm
L_g2d_e2:
    s_cmp_lg_u32 s54, 3
    s_cbranch_scc1 L_g2d_e3
    s_waitcnt lgkmcnt(8)
    v_pk_add_f32 v[48:49], v[48:49], v[72:73]
    v_pk_add_f32 v[50:51], v[50:51], v[74:75]
    v_pk_add_f32 v[52:53], v[52:53], v[76:77]
    v_pk_add_f32 v[54:55], v[54:55], v[78:79]
    v_pk_add_f32 v[56:57], v[56:57], v[80:81]
    v_pk_add_f32 v[58:59], v[58:59], v[82:83]
    v_pk_add_f32 v[60:61], v[60:61], v[84:85]
    v_pk_add_f32 v[62:63], v[62:63], v[86:87]
    s_waitcnt lgkmcnt(4)
    v_pk_add_f32 v[48:49], v[48:49], v[88:89]
    v_pk_add_f32 v[50:51], v[50:51], v[90:91]
    v_pk_add_f32 v[52:53], v[52:53], v[92:93]
    v_pk_add_f32 v[54:55], v[54:55], v[94:95]
    v_pk_add_f32 v[56:57], v[56:57], v[96:97]
    v_pk_add_f32 v[58:59], v[58:59], v[98:99]
    v_pk_add_f32 v[60:61], v[60:61], v[100:101]
    v_pk_add_f32 v[62:63], v[62:63], v[102:103]
    s_waitcnt lgkmcnt(0)
    v_pk_add_f32 v[48:49], v[48:49], v[104:105]
    v_pk_add_f32 v[50:51], v[50:51], v[106:107]
    v_pk_add_f32 v[52:53], v[52:53], v[108:109]
    v_pk_add_f32 v[54:55], v[54:55], v[110:111]
    v_pk_add_f32 v[56:57], v[56:57], v[112:113]
    v_pk_add_f32 v[58:59], v[58:59], v[114:115]
    v_pk_add_f32 v[60:61], v[60:61], v[116:117]
    v_pk_add_f32 v[62:63], v[62:63], v[118:119]
    v_cvt_pk_bf16_f32 v128, v48, v49
    v_cvt_pk_bf16_f32 v130, v50, v51
    v_cvt_pk_bf16_f32 v132, v52, v53
    v_cvt_pk_bf16_f32 v134, v54, v55
    v_cvt_pk_bf16_f32 v136, v56, v57
    v_cvt_pk_bf16_f32 v138, v58, v59
    v_cvt_pk_bf16_f32 v140, v60, v61
    v_cvt_pk_bf16_f32 v142, v62, v63
    v_lshlrev_b32 v48, 16, v128
    v_and_b32 v49, 0xffff0000, v128
    v_lshlrev_b32 v50, 16, v130
    v_and_b32 v51, 0xffff0000, v130
    v_lshlrev_b32 v52, 16, v132
    v_and_b32 v53, 0xffff0000, v132
    v_lshlrev_b32 v54, 16, v134
    v_and_b32 v55, 0xffff0000, v134
    v_lshlrev_b32 v56, 16, v136
    v_and_b32 v57, 0xffff0000, v136
    v_lshlrev_b32 v58, 16, v138
    v_and_b32 v59, 0xffff0000, v138
    v_lshlrev_b32 v60, 16, v140
    v_and_b32 v61, 0xffff0000, v140
    v_lshlrev_b32 v62, 16, v142
    v_and_b32 v63, 0xffff0000, v142
    v_pk_mul_f32 v[128:129], v[48:49], s[60:61]
    v_pk_mul_f32 v[130:131], v[50:51], s[60:61]
    v_pk_mul_f32 v[132:133], v[52:53], s[60:61]
    v_pk_mul_f32 v[134:135], v[54:55], s[60:61]
    v_pk_mul_f32 v[136:137], v[56:57], s[60:61]
    v_pk_mul_f32 v[138:139], v[58:59], s[60:61]
    v_pk_mul_f32 v[140:141], v[60:61], s[60:61]
    v_pk_mul_f32 v[142:143], v[62:63], s[60:61]
    v_exp_f32 v128, v128
    v_exp_f32 v129, v129
    v_exp_f32 v130, v130
    v_exp_f32 v131, v131
    v_exp_f32 v132, v132
    v_exp_f32 v133, v133
    v_exp_f32 v134, v134
    v_exp_f32 v135, v135
    v_exp_f32 v136, v136
    v_exp_f32 v137, v137
    v_exp_f32 v138, v138
    v_exp_f32 v139, v139
    v_exp_f32 v140, v140
    v_exp_f32 v141, v141
    v_exp_f32 v142, v142
    v_exp_f32 v143, v143
    v_pk_add_f32 v[128:129], v[128:129], s[62:63]
    v_pk_add_f32 v[130:131], v[130:131], s[62:63]
    v_pk_add_f32 v[132:133], v[132:133], s[62:63]
    v_pk_add_f32 v[134:135], v[134:135], s[62:63]
    v_pk_add_f32 v[136:137], v[136:137], s[62:63]
    v_pk_add_f32 v[138:139], v[138:139], s[62:63]
    v_pk_add_f32 v[140:141], v[140:141], s[62:63]
    v_pk_add_f32 v[142:143], v[142:143], s[62:63]
    v_rcp_f32 v128, v128
    v_rcp_f32 v129, v129
    v_rcp_f32 v130, v130
    v_rcp_f32 v131, v131
    v_rcp_f32 v132, v132
    v_rcp_f32 v133, v133
    v_rcp_f32 v134, v134
    v_rcp_f32 v135, v135
    v_rcp_f32 v136, v136
    v_rcp_f32 v137, v137
    v_rcp_f32 v138, v138
    v_rcp_f32 v139, v139
    v_rcp_f32 v140, v140
    v_rcp_f32 v141, v141
    v_rcp_f32 v142, v142
    v_rcp_f32 v143, v143
    v_pk_mul_f32 v[48:49], v[48:49], v[128:129]
    v_pk_mul_f32 v[50:51], v[50:51], v[130:131]
    v_pk_mul_f32 v[52:53], v[52:53], v[132:133]
    v_pk_mul_f32 v[54:55], v[54:55], v[134:135]
    v_pk_mul_f32 v[56:57], v[56:57], v[136:137]
    v_pk_mul_f32 v[58:59], v[58:59], v[138:139]
    v_pk_mul_f32 v[60:61], v[60:61], v[140:141]
    v_pk_mul_f32 v[62:63], v[62:63], v[142:143]
    v_cvt_pk_bf16_f32 v48, v48, v49
    v_cvt_pk_bf16_f32 v49, v50, v51
    v_cvt_pk_bf16_f32 v52, v52, v53
    v_cvt_pk_bf16_f32 v53, v54, v55
    v_cvt_pk_bf16_f32 v56, v56, v57
    v_cvt_pk_bf16_f32 v57, v58, v59
    v_cvt_pk_bf16_f32 v60, v60, v61
    v_cvt_pk_bf16_f32 v61, v62, v63
    buffer_store_dwordx2 v[48:49], v70, s[24:27], s52 offen offset:0
    buffer_store_dwordx2 v[52:53], v70, s[24:27], s52 offen offset:32
    buffer_store_dwordx2 v[56:57], v70, s[24:27], s52 offen offset:64
    buffer_store_dwordx2 v[60:61], v70, s[24:27], s52 offen offset:96
    s_waitcnt lgkmcnt(0)
    s_endpgm
L_g2d_e3:
L_g2_done:
    s_endpgm
L_g2_cols:
    s_setprio 3
    s_sub_u32 s2, s2, 256
    s_load_dwordx2 s[10:11], s[0:1], 72
    s_mov_b32 s36, 0x3f3504f3
    s_lshl_b32 s40, s2, 14
    s_add_u32 s41, s40, 4096
    s_add_u32 s42, s40, 8192
    s_add_u32 s43, s40, 12288
    s_lshl_b32 s44, s2, 13
    s_add_u32 s45, s44, 4096
    v_lshlrev_b32 v104, 3, v0
    v_lshlrev_b32 v103, 2, v0
    s_waitcnt lgkmcnt(0)
    s_mov_b32 s24, s10
    s_mov_b32 s25, s11
    s_mov_b32 s26, 0x404000
    s_mov_b32 s27, 0x00020000
    s_add_u32 s28, s10, 0x500000
    s_addc_u32 s29, s11, 0
    s_mov_b32 s30, 0x202000
    s_mov_b32 s31, 0x00020000
    buffer_load_dwordx2 v[8:9], v104, s[24:27], s40 offen offset:0
    buffer_load_dwordx2 v[10:11], v104, s[24:27], s40 offen offset:2048
    buffer_load_dwordx2 v[12:13], v104, s[24:27], s41 offen offset:0
    buffer_load_dwordx2 v[14:15], v104, s[24:27], s41 offen offset:2048
    buffer_load_dwordx2 v[16:17], v104, s[24:27], s42 offen offset:0
    buffer_load_dwordx2 v[18:19], v104, s[24:27], s42 offen offset:2048
    buffer_load_dwordx2 v[20:21], v104, s[24:27], s43 offen offset:0
    buffer_load_dwordx2 v[22:23], v104, s[24:27], s43 offen offset:2048
    buffer_load_dword v96, v103, s[28:31], s44 offen offset:0
    buffer_load_dword v97, v103, s[28:31], s44 offen offset:1024
    buffer_load_dword v98, v103, s[28:31], s44 offen offset:2048
    buffer_load_dword v99, v103, s[28:31], s44 offen offset:3072
    buffer_load_dword v100, v103, s[28:31], s45 offen offset:0
    buffer_load_dword v101, v103, s[28:31], s45 offen offset:1024
    buffer_load_dword v102, v103, s[28:31], s45 offen offset:2048
    buffer_load_dword v103, v103, s[28:31], s45 offen offset:3072
    v_lshrrev_b32 v116, 5, v0
    v_cvt_f32_u32 v116, v116
    v_mul_f32 v116, 0xbc800000, v116
    v_mul_f32 v117, 0x3f800000, v116
    v_cos_f32 v50, v117
    v_sin_f32 v51, v117
    v_mul_f32 v117, 0x40000000, v116
    v_cos_f32 v52, v117
    v_sin_f32 v53, v117
    v_mul_f32 v117, 0x40400000, v116
    v_cos_f32 v54, v117
    v_sin_f32 v55, v117
    v_mul_f32 v117, 0x40800000, v116
    v_cos_f32 v56, v117
    v_sin_f32 v57, v117
    v_mul_f32 v117, 0x40a00000, v116
    v_cos_f32 v58, v117
    v_sin_f32 v59, v117
    v_mul_f32 v117, 0x40c00000, v116
    v_cos_f32 v60, v117
    v_sin_f32 v61, v117
    v_mul_f32 v117, 0x40e00000, v116
    v_cos_f32 v62, v117
    v_sin_f32 v63, v117
    v_lshrrev_b32 v116, 5, v0
    v_bfe_u32 v117, v0, 2, 3
    v_mul_u32_u24 v118, v116, v117
    v_cvt_f32_u32 v118, v118
    v_cvt_f32_u32 v116, v117
    v_mul_f32 v118, 0xbb000000, v118
    v_mul_f32 v116, 0xbc800000, v116
    v_mov_b32 v119, 0x0
    v_fma_f32 v117, v116, v119, v118
    v_cos_f32 v64, v117
    v_sin_f32 v65, v117
    v_mov_b32 v119, 0x3f800000
    v_fma_f32 v117, v116, v119, v118
    v_cos_f32 v66, v117
    v_sin_f32 v67, v117
    v_mov_b32 v119, 0x40000000
    v_fma_f32 v117, v116, v119, v118
    v_cos_f32 v68, v117
    v_sin_f32 v69, v117
    v_mov_b32 v119, 0x40400000
    v_fma_f32 v117, v116, v119, v118
    v_cos_f32 v70, v117
    v_sin_f32 v71, v117
    v_mov_b32 v119, 0x40800000
    v_fma_f32 v117, v116, v119, v118
    v_cos_f32 v72, v117
    v_sin_f32 v73, v117
    v_mov_b32 v119, 0x40a00000
    v_fma_f32 v117, v116, v119, v118
    v_cos_f32 v74, v117
    v_sin_f32 v75, v117
    v_mov_b32 v119, 0x40c00000
    v_fma_f32 v117, v116, v119, v118
    v_cos_f32 v76, v117
    v_sin_f32 v77, v117
    v_mov_b32 v119, 0x40e00000
    v_fma_f32 v117, v116, v119, v118
    v_cos_f32 v78, v117
    v_sin_f32 v79, v117
    v_and_b32 v116, 3, v0
    v_lshrrev_b32 v117, 2, v0
    v_mul_u32_u24 v118, v116, v117
    v_cvt_f32_u32 v118, v118
    v_cvt_f32_u32 v116, v116
    v_mul_f32 v118, 0xba000000, v118
    v_mul_f32 v116, 0xbd000000, v116
    v_mov_b32 v119, 0x0
    v_fma_f32 v117, v116, v119, v118
    v_cos_f32 v80, v117
    v_sin_f32 v81, v117
    v_mov_b32 v119, 0x3f800000
    v_fma_f32 v117, v116, v119, v118
    v_cos_f32 v82, v117
    v_sin_f32 v83, v117
    v_mov_b32 v119, 0x40000000
    v_fma_f32 v117, v116, v119, v118
    v_cos_f32 v84, v117
    v_sin_f32 v85, v117
    v_mov_b32 v119, 0x40400000
    v_fma_f32 v117, v116, v119, v118
    v_cos_f32 v86, v117
    v_sin_f32 v87, v117
    v_mov_b32 v119, 0x40800000
    v_fma_f32 v117, v116, v119, v118
    v_cos_f32 v88, v117
    v_sin_f32 v89, v117
    v_mov_b32 v119, 0x40a00000
    v_fma_f32 v117, v116, v119, v118
    v_cos_f32 v90, v117
    v_sin_f32 v91, v117
    v_mov_b32 v119, 0x40c00000
    v_fma_f32 v117, v116, v119, v118
    v_cos_f32 v92, v117
    v_sin_f32 v93, v117
    v_mov_b32 v119, 0x40e00000
    v_fma_f32 v117, v116, v119, v118
    v_cos_f32 v94, v117
    v_sin_f32 v95, v117
    v_lshrrev_b32 v116, 5, v0
    v_and_b32 v117, 31, v0
    v_lshl_add_u32 v118, v116, 8, v117
    v_lshlrev_b32 v105, 3, v118
    v_mul_u32_u24 v118, 36, v116
    v_add_u32 v118, v118, v117
    v_lshlrev_b32 v106, 3, v118
    v_mul_u32_u24 v118, 288, v116
    v_bfe_u32 v117, v0, 2, 3
    v_mul_u32_u24 v119, 36, v117
    v_add_u32 v118, v118, v119
    v_and_b32 v117, 3, v0
    v_add_u32 v118, v118, v117
    v_lshlrev_b32 v107, 3, v118
    v_lshlrev_b32 v108, 5, v0
    s_waitcnt vmcnt(8)
    v_add_f32 v24, v8, v16
    v_add_f32 v25, v9, v17
    v_sub_f32 v32, v8, v16
    v_sub_f32 v33, v9, v17
    v_add_f32 v26, v10, v18
    v_add_f32 v27, v11, v19
    v_sub_f32 v34, v10, v18
    v_sub_f32 v35, v11, v19
    v_add_f32 v28, v12, v20
    v_add_f32 v29, v13, v21
    v_sub_f32 v36, v12, v20
    v_sub_f32 v37, v13, v21
    v_add_f32 v30, v14, v22
    v_add_f32 v31, v15, v23
    v_sub_f32 v38, v14, v22
    v_sub_f32 v39, v15, v23
    v_add_f32 v40, v34, v35
    v_sub_f32 v41, v35, v34
    v_mul_f32 v34, s36, v40
    v_mul_f32 v35, s36, v41
    v_sub_f32 v40, v39, v38
    v_add_f32 v41, v38, v39
    v_mul_f32 v38, s36, v40
    v_mul_f32 v39, s36, v41
    v_sub_f32 v39, 0, v39
    v_sub_f32 v40, 0, v36
    v_mov_b32 v36, v37
    v_mov_b32 v37, v40
    v_add_f32 v40, v24, v28
    v_add_f32 v41, v25, v29
    v_sub_f32 v42, v24, v28
    v_sub_f32 v43, v25, v29
    v_add_f32 v44, v26, v30
    v_add_f32 v45, v27, v31
    v_sub_f32 v46, v26, v30
    v_sub_f32 v47, v27, v31
    v_add_f32 v8, v40, v44
    v_add_f32 v9, v41, v45
    v_sub_f32 v16, v40, v44
    v_sub_f32 v17, v41, v45
    v_add_f32 v12, v42, v47
    v_sub_f32 v13, v43, v46
    v_sub_f32 v20, v42, v47
    v_add_f32 v21, v43, v46
    v_add_f32 v40, v32, v36
    v_add_f32 v41, v33, v37
    v_sub_f32 v42, v32, v36
    v_sub_f32 v43, v33, v37
    v_add_f32 v44, v34, v38
    v_add_f32 v45, v35, v39
    v_sub_f32 v46, v34, v38
    v_sub_f32 v47, v35, v39
    v_add_f32 v10, v40, v44
    v_add_f32 v11, v41, v45
    v_sub_f32 v18, v40, v44
    v_sub_f32 v19, v41, v45
    v_add_f32 v14, v42, v47
    v_sub_f32 v15, v43, v46
    v_sub_f32 v22, v42, v47
    v_add_f32 v23, v43, v46
    v_mul_f32 v116, v11, v51
    v_mul_f32 v117, v10, v51
    v_fma_f32 v10, v10, v50, -v116
    v_fma_f32 v11, v11, v50, v117
    v_mul_f32 v116, v13, v53
    v_mul_f32 v117, v12, v53
    v_fma_f32 v12, v12, v52, -v116
    v_fma_f32 v13, v13, v52, v117
    v_mul_f32 v116, v15, v55
    v_mul_f32 v117, v14, v55
    v_fma_f32 v14, v14, v54, -v116
    v_fma_f32 v15, v15, v54, v117
    v_mul_f32 v116, v17, v57
    v_mul_f32 v117, v16, v57
    v_fma_f32 v16, v16, v56, -v116
    v_fma_f32 v17, v17, v56, v117
    v_mul_f32 v116, v19, v59
    v_mul_f32 v117, v18, v59
    v_fma_f32 v18, v18, v58, -v116
    v_fma_f32 v19, v19, v58, v117
    v_mul_f32 v116, v21, v61
    v_mul_f32 v117, v20, v61
    v_fma_f32 v20, v20, v60, -v116
    v_fma_f32 v21, v21, v60, v117
    v_mul_f32 v116, v23, v63
    v_mul_f32 v117, v22, v63
    v_fma_f32 v22, v22, v62, -v116
    v_fma_f32 v23, v23, v62, v117
    ds_write_b64 v104, v[8:9] offset:0
    ds_write_b64 v104, v[10:11] offset:2048
    ds_write_b64 v104, v[12:13] offset:4096
    ds_write_b64 v104, v[14:15] offset:6144
    ds_write_b64 v104, v[16:17] offset:8192
    ds_write_b64 v104, v[18:19] offset:10240
    ds_write_b64 v104, v[20:21] offset:12288
    ds_write_b64 v104, v[22:23] offset:14336
    s_waitcnt lgkmcnt(0)
    s_barrier
    ds_read_b64 v[8:9], v105 offset:0
    ds_read_b64 v[10:11], v105 offset:256
    ds_read_b64 v[12:13], v105 offset:512
    ds_read_b64 v[14:15], v105 offset:768
    ds_read_b64 v[16:17], v105 offset:1024
    ds_read_b64 v[18:19], v105 offset:1280
    ds_read_b64 v[20:21], v105 offset:1536
    ds_read_b64 v[22:23], v105 offset:1792
    s_waitcnt lgkmcnt(0)
    v_add_f32 v24, v8, v16
    v_add_f32 v25, v9, v17
    v_sub_f32 v32, v8, v16
    v_sub_f32 v33, v9, v17
    v_add_f32 v26, v10, v18
    v_add_f32 v27, v11, v19
    v_sub_f32 v34, v10, v18
    v_sub_f32 v35, v11, v19
    v_add_f32 v28, v12, v20
    v_add_f32 v29, v13, v21
    v_sub_f32 v36, v12, v20
    v_sub_f32 v37, v13, v21
    v_add_f32 v30, v14, v22
    v_add_f32 v31, v15, v23
    v_sub_f32 v38, v14, v22
    v_sub_f32 v39, v15, v23
    v_add_f32 v40, v34, v35
    v_sub_f32 v41, v35, v34
    v_mul_f32 v34, s36, v40
    v_mul_f32 v35, s36, v41
    v_sub_f32 v40, v39, v38
    v_add_f32 v41, v38, v39
    v_mul_f32 v38, s36, v40
    v_mul_f32 v39, s36, v41
    v_sub_f32 v39, 0, v39
    v_sub_f32 v40, 0, v36
    v_mov_b32 v36, v37
    v_mov_b32 v37, v40
    v_add_f32 v40, v24, v28
    v_add_f32 v41, v25, v29
    v_sub_f32 v42, v24, v28
    v_sub_f32 v43, v25, v29
    v_add_f32 v44, v26, v30
    v_add_f32 v45, v27, v31
    v_sub_f32 v46, v26, v30
    v_sub_f32 v47, v27, v31
    v_add_f32 v8, v40, v44
    v_add_f32 v9, v41, v45
    v_sub_f32 v16, v40, v44
    v_sub_f32 v17, v41, v45
    v_add_f32 v12, v42, v47
    v_sub_f32 v13, v43, v46
    v_sub_f32 v20, v42, v47
    v_add_f32 v21, v43, v46
    v_add_f32 v40, v32, v36
    v_add_f32 v41, v33, v37
    v_sub_f32 v42, v32, v36
    v_sub_f32 v43, v33, v37
    v_add_f32 v44, v34, v38
    v_add_f32 v45, v35, v39
    v_sub_f32 v46, v34, v38
    v_sub_f32 v47, v35, v39
    v_add_f32 v10, v40, v44
    v_add_f32 v11, v41, v45
    v_sub_f32 v18, v40, v44
    v_sub_f32 v19, v41, v45
    v_add_f32 v14, v42, v47
    v_sub_f32 v15, v43, v46
    v_sub_f32 v22, v42, v47
    v_add_f32 v23, v43, v46
    v_mul_f32 v116, v9, v65
    v_mul_f32 v117, v8, v65
    v_fma_f32 v8, v8, v64, -v116
    v_fma_f32 v9, v9, v64, v117
    v_mul_f32 v116, v11, v67
    v_mul_f32 v117, v10, v67
    v_fma_f32 v10, v10, v66, -v116
    v_fma_f32 v11, v11, v66, v117
    v_mul_f32 v116, v13, v69
    v_mul_f32 v117, v12, v69
    v_fma_f32 v12, v12, v68, -v116
    v_fma_f32 v13, v13, v68, v117
    v_mul_f32 v116, v15, v71
    v_mul_f32 v117, v14, v71
    v_fma_f32 v14, v14, v70, -v116
    v_fma_f32 v15, v15, v70, v117
    v_mul_f32 v116, v17, v73
    v_mul_f32 v117, v16, v73
    v_fma_f32 v16, v16, v72, -v116
    v_fma_f32 v17, v17, v72, v117
    v_mul_f32 v116, v19, v75
    v_mul_f32 v117, v18, v75
    v_fma_f32 v18, v18, v74, -v116
    v_fma_f32 v19, v19, v74, v117
    v_mul_f32 v116, v21, v77
    v_mul_f32 v117, v20, v77
    v_fma_f32 v20, v20, v76, -v116
    v_fma_f32 v21, v21, v76, v117
    v_mul_f32 v116, v23, v79
    v_mul_f32 v117, v22, v79
    v_fma_f32 v22, v22, v78, -v116
    v_fma_f32 v23, v23, v78, v117
    ds_write_b64 v106, v[8:9] offset:18432
    ds_write_b64 v106, v[10:11] offset:20736
    ds_write_b64 v106, v[12:13] offset:23040
    ds_write_b64 v106, v[14:15] offset:25344
    ds_write_b64 v106, v[16:17] offset:27648
    ds_write_b64 v106, v[18:19] offset:29952
    ds_write_b64 v106, v[20:21] offset:32256
    ds_write_b64 v106, v[22:23] offset:34560
    s_waitcnt lgkmcnt(0)
    s_barrier
    ds_read_b64 v[8:9], v107 offset:18432
    ds_read_b64 v[10:11], v107 offset:18464
    ds_read_b64 v[12:13], v107 offset:18496
    ds_read_b64 v[14:15], v107 offset:18528
    ds_read_b64 v[16:17], v107 offset:18560
    ds_read_b64 v[18:19], v107 offset:18592
    ds_read_b64 v[20:21], v107 offset:18624
    ds_read_b64 v[22:23], v107 offset:18656
    s_waitcnt lgkmcnt(0)
    v_add_f32 v24, v8, v16
    v_add_f32 v25, v9, v17
    v_sub_f32 v32, v8, v16
    v_sub_f32 v33, v9, v17
    v_add_f32 v26, v10, v18
    v_add_f32 v27, v11, v19
    v_sub_f32 v34, v10, v18
    v_sub_f32 v35, v11, v19
    v_add_f32 v28, v12, v20
    v_add_f32 v29, v13, v21
    v_sub_f32 v36, v12, v20
    v_sub_f32 v37, v13, v21
    v_add_f32 v30, v14, v22
    v_add_f32 v31, v15, v23
    v_sub_f32 v38, v14, v22
    v_sub_f32 v39, v15, v23
    v_add_f32 v40, v34, v35
    v_sub_f32 v41, v35, v34
    v_mul_f32 v34, s36, v40
    v_mul_f32 v35, s36, v41
    v_sub_f32 v40, v39, v38
    v_add_f32 v41, v38, v39
    v_mul_f32 v38, s36, v40
    v_mul_f32 v39, s36, v41
    v_sub_f32 v39, 0, v39
    v_sub_f32 v40, 0, v36
    v_mov_b32 v36, v37
    v_mov_b32 v37, v40
    v_add_f32 v40, v24, v28
    v_add_f32 v41, v25, v29
    v_sub_f32 v42, v24, v28
    v_sub_f32 v43, v25, v29
    v_add_f32 v44, v26, v30
    v_add_f32 v45, v27, v31
    v_sub_f32 v46, v26, v30
    v_sub_f32 v47, v27, v31
    v_add_f32 v8, v40, v44
    v_add_f32 v9, v41, v45
    v_sub_f32 v16, v40, v44
    v_sub_f32 v17, v41, v45
    v_add_f32 v12, v42, v47
    v_sub_f32 v13, v43, v46
    v_sub_f32 v20, v42, v47
    v_add_f32 v21, v43, v46
    v_add_f32 v40, v32, v36
    v_add_f32 v41, v33, v37
    v_sub_f32 v42, v32, v36
    v_sub_f32 v43, v33, v37
    v_add_f32 v44, v34, v38
    v_add_f32 v45, v35, v39
    v_sub_f32 v46, v34, v38
    v_sub_f32 v47, v35, v39
    v_add_f32 v10, v40, v44
    v_add_f32 v11, v41, v45
    v_sub_f32 v18, v40, v44
    v_sub_f32 v19, v41, v45
    v_add_f32 v14, v42, v47
    v_sub_f32 v15, v43, v46
    v_sub_f32 v22, v42, v47
    v_add_f32 v23, v43, v46
    v_mul_f32 v116, v9, v81
    v_mul_f32 v117, v8, v81
    v_fma_f32 v8, v8, v80, -v116
    v_fma_f32 v9, v9, v80, v117
    v_mul_f32 v116, v11, v83
    v_mul_f32 v117, v10, v83
    v_fma_f32 v10, v10, v82, -v116
    v_fma_f32 v11, v11, v82, v117
    v_mul_f32 v116, v13, v85
    v_mul_f32 v117, v12, v85
    v_fma_f32 v12, v12, v84, -v116
    v_fma_f32 v13, v13, v84, v117
    v_mul_f32 v116, v15, v87
    v_mul_f32 v117, v14, v87
    v_fma_f32 v14, v14, v86, -v116
    v_fma_f32 v15, v15, v86, v117
    v_mul_f32 v116, v17, v89
    v_mul_f32 v117, v16, v89
    v_fma_f32 v16, v16, v88, -v116
    v_fma_f32 v17, v17, v88, v117
    v_mul_f32 v116, v19, v91
    v_mul_f32 v117, v18, v91
    v_fma_f32 v18, v18, v90, -v116
    v_fma_f32 v19, v19, v90, v117
    v_mul_f32 v116, v21, v93
    v_mul_f32 v117, v20, v93
    v_fma_f32 v20, v20, v92, -v116
    v_fma_f32 v21, v21, v92, v117
    v_mul_f32 v116, v23, v95
    v_mul_f32 v117, v22, v95
    v_fma_f32 v22, v22, v94, -v116
    v_fma_f32 v23, v23, v94, v117
    ds_write_b64 v104, v[8:9] offset:0
    ds_write_b64 v104, v[10:11] offset:2048
    ds_write_b64 v104, v[12:13] offset:4096
    ds_write_b64 v104, v[14:15] offset:6144
    ds_write_b64 v104, v[16:17] offset:8192
    ds_write_b64 v104, v[18:19] offset:10240
    ds_write_b64 v104, v[20:21] offset:12288
    ds_write_b64 v104, v[22:23] offset:14336
    s_waitcnt lgkmcnt(0)
    s_barrier
    ds_read_b128 v[8:11], v108 offset:0
    ds_read_b128 v[12:15], v108 offset:16
    ds_read_b128 v[16:19], v108 offset:8192
    ds_read_b128 v[20:23], v108 offset:8208
    s_waitcnt lgkmcnt(0)
    v_add_f32 v40, v8, v12
    v_add_f32 v41, v9, v13
    v_sub_f32 v42, v8, v12
    v_sub_f32 v43, v9, v13
    v_add_f32 v44, v10, v14
    v_add_f32 v45, v11, v15
    v_sub_f32 v46, v10, v14
    v_sub_f32 v47, v11, v15
    v_add_f32 v8, v40, v44
    v_add_f32 v9, v41, v45
    v_sub_f32 v12, v40, v44
    v_sub_f32 v13, v41, v45
    v_add_f32 v10, v42, v47
    v_sub_f32 v11, v43, v46
    v_sub_f32 v14, v42, v47
    v_add_f32 v15, v43, v46
    v_add_f32 v40, v16, v20
    v_add_f32 v41, v17, v21
    v_sub_f32 v42, v16, v20
    v_sub_f32 v43, v17, v21
    v_add_f32 v44, v18, v22
    v_add_f32 v45, v19, v23
    v_sub_f32 v46, v18, v22
    v_sub_f32 v47, v19, v23
    v_add_f32 v16, v40, v44
    v_add_f32 v17, v41, v45
    v_sub_f32 v20, v40, v44
    v_sub_f32 v21, v41, v45
    v_add_f32 v18, v42, v47
    v_sub_f32 v19, v43, v46
    v_sub_f32 v22, v42, v47
    v_add_f32 v23, v43, v46
    s_waitcnt vmcnt(0)
    v_lshlrev_b32 v118, 16, v96
    v_and_b32 v119, 0xffff0000, v96
    v_mul_f32 v118, 0x35000000, v118
    v_mul_f32 v119, 0x35000000, v119
    v_mul_f32 v116, v9, v119
    v_mul_f32 v117, v8, v119
    v_fma_f32 v8, v8, v118, -v116
    v_fma_f32 v9, v9, v118, v117
    v_lshlrev_b32 v118, 16, v97
    v_and_b32 v119, 0xffff0000, v97
    v_mul_f32 v118, 0x35000000, v118
    v_mul_f32 v119, 0x35000000, v119
    v_mul_f32 v116, v17, v119
    v_mul_f32 v117, v16, v119
    v_fma_f32 v16, v16, v118, -v116
    v_fma_f32 v17, v17, v118, v117
    v_lshlrev_b32 v118, 16, v98
    v_and_b32 v119, 0xffff0000, v98
    v_mul_f32 v118, 0x35000000, v118
    v_mul_f32 v119, 0x35000000, v119
    v_mul_f32 v116, v11, v119
    v_mul_f32 v117, v10, v119
    v_fma_f32 v10, v10, v118, -v116
    v_fma_f32 v11, v11, v118, v117
    v_lshlrev_b32 v118, 16, v99
    v_and_b32 v119, 0xffff0000, v99
    v_mul_f32 v118, 0x35000000, v118
    v_mul_f32 v119, 0x35000000, v119
    v_mul_f32 v116, v19, v119
    v_mul_f32 v117, v18, v119
    v_fma_f32 v18, v18, v118, -v116
    v_fma_f32 v19, v19, v118, v117
    v_lshlrev_b32 v118, 16, v100
    v_and_b32 v119, 0xffff0000, v100
    v_mul_f32 v118, 0x35000000, v118
    v_mul_f32 v119, 0x35000000, v119
    v_mul_f32 v116, v13, v119
    v_mul_f32 v117, v12, v119
    v_fma_f32 v12, v12, v118, -v116
    v_fma_f32 v13, v13, v118, v117
    v_lshlrev_b32 v118, 16, v101
    v_and_b32 v119, 0xffff0000, v101
    v_mul_f32 v118, 0x35000000, v118
    v_mul_f32 v119, 0x35000000, v119
    v_mul_f32 v116, v21, v119
    v_mul_f32 v117, v20, v119
    v_fma_f32 v20, v20, v118, -v116
    v_fma_f32 v21, v21, v118, v117
    v_lshlrev_b32 v118, 16, v102
    v_and_b32 v119, 0xffff0000, v102
    v_mul_f32 v118, 0x35000000, v118
    v_mul_f32 v119, 0x35000000, v119
    v_mul_f32 v116, v15, v119
    v_mul_f32 v117, v14, v119
    v_fma_f32 v14, v14, v118, -v116
    v_fma_f32 v15, v15, v118, v117
    v_lshlrev_b32 v118, 16, v103
    v_and_b32 v119, 0xffff0000, v103
    v_mul_f32 v118, 0x35000000, v118
    v_mul_f32 v119, 0x35000000, v119
    v_mul_f32 v116, v23, v119
    v_mul_f32 v117, v22, v119
    v_fma_f32 v22, v22, v118, -v116
    v_fma_f32 v23, v23, v118, v117
    v_add_f32 v40, v8, v12
    v_add_f32 v41, v9, v13
    v_sub_f32 v42, v8, v12
    v_sub_f32 v43, v9, v13
    v_add_f32 v44, v10, v14
    v_add_f32 v45, v11, v15
    v_sub_f32 v46, v10, v14
    v_sub_f32 v47, v11, v15
    v_add_f32 v8, v40, v44
    v_add_f32 v9, v41, v45
    v_sub_f32 v12, v40, v44
    v_sub_f32 v13, v41, v45
    v_sub_f32 v10, v42, v47
    v_add_f32 v11, v43, v46
    v_add_f32 v14, v42, v47
    v_sub_f32 v15, v43, v46
    v_add_f32 v40, v16, v20
    v_add_f32 v41, v17, v21
    v_sub_f32 v42, v16, v20
    v_sub_f32 v43, v17, v21
    v_add_f32 v44, v18, v22
    v_add_f32 v45, v19, v23
    v_sub_f32 v46, v18, v22
    v_sub_f32 v47, v19, v23
    v_add_f32 v16, v40, v44
    v_add_f32 v17, v41, v45
    v_sub_f32 v20, v40, v44
    v_sub_f32 v21, v41, v45
    v_sub_f32 v18, v42, v47
    v_add_f32 v19, v43, v46
    v_add_f32 v22, v42, v47
    v_sub_f32 v23, v43, v46
    ds_write_b128 v108, v[8:11] offset:18432
    ds_write_b128 v108, v[12:15] offset:18448
    ds_write_b128 v108, v[16:19] offset:26624
    ds_write_b128 v108, v[20:23] offset:26640
    s_waitcnt lgkmcnt(0)
    s_barrier
    ds_read_b64 v[8:9], v104 offset:18432
    ds_read_b64 v[10:11], v104 offset:20480
    ds_read_b64 v[12:13], v104 offset:22528
    ds_read_b64 v[14:15], v104 offset:24576
    ds_read_b64 v[16:17], v104 offset:26624
    ds_read_b64 v[18:19], v104 offset:28672
    ds_read_b64 v[20:21], v104 offset:30720
    ds_read_b64 v[22:23], v104 offset:32768
    s_waitcnt lgkmcnt(0)
    v_mul_f32 v116, v9, v81
    v_mul_f32 v117, v8, v81
    v_fma_f32 v8, v8, v80, v116
    v_fma_f32 v9, v9, v80, -v117
    v_mul_f32 v116, v11, v83
    v_mul_f32 v117, v10, v83
    v_fma_f32 v10, v10, v82, v116
    v_fma_f32 v11, v11, v82, -v117
    v_mul_f32 v116, v13, v85
    v_mul_f32 v117, v12, v85
    v_fma_f32 v12, v12, v84, v116
    v_fma_f32 v13, v13, v84, -v117
    v_mul_f32 v116, v15, v87
    v_mul_f32 v117, v14, v87
    v_fma_f32 v14, v14, v86, v116
    v_fma_f32 v15, v15, v86, -v117
    v_mul_f32 v116, v17, v89
    v_mul_f32 v117, v16, v89
    v_fma_f32 v16, v16, v88, v116
    v_fma_f32 v17, v17, v88, -v117
    v_mul_f32 v116, v19, v91
    v_mul_f32 v117, v18, v91
    v_fma_f32 v18, v18, v90, v116
    v_fma_f32 v19, v19, v90, -v117
    v_mul_f32 v116, v21, v93
    v_mul_f32 v117, v20, v93
    v_fma_f32 v20, v20, v92, v116
    v_fma_f32 v21, v21, v92, -v117
    v_mul_f32 v116, v23, v95
    v_mul_f32 v117, v22, v95
    v_fma_f32 v22, v22, v94, v116
    v_fma_f32 v23, v23, v94, -v117
    v_add_f32 v24, v8, v16
    v_add_f32 v25, v9, v17
    v_sub_f32 v32, v8, v16
    v_sub_f32 v33, v9, v17
    v_add_f32 v26, v10, v18
    v_add_f32 v27, v11, v19
    v_sub_f32 v34, v10, v18
    v_sub_f32 v35, v11, v19
    v_add_f32 v28, v12, v20
    v_add_f32 v29, v13, v21
    v_sub_f32 v36, v12, v20
    v_sub_f32 v37, v13, v21
    v_add_f32 v30, v14, v22
    v_add_f32 v31, v15, v23
    v_sub_f32 v38, v14, v22
    v_sub_f32 v39, v15, v23
    v_sub_f32 v40, v34, v35
    v_add_f32 v41, v34, v35
    v_mul_f32 v34, s36, v40
    v_mul_f32 v35, s36, v41
    v_add_f32 v40, v38, v39
    v_sub_f32 v41, v38, v39
    v_mul_f32 v38, s36, v40
    v_mul_f32 v39, s36, v41
    v_sub_f32 v38, 0, v38
    v_sub_f32 v40, 0, v37
    v_mov_b32 v37, v36
    v_mov_b32 v36, v40
    v_add_f32 v40, v24, v28
    v_add_f32 v41, v25, v29
    v_sub_f32 v42, v24, v28
    v_sub_f32 v43, v25, v29
    v_add_f32 v44, v26, v30
    v_add_f32 v45, v27, v31
    v_sub_f32 v46, v26, v30
    v_sub_f32 v47, v27, v31
    v_add_f32 v8, v40, v44
    v_add_f32 v9, v41, v45
    v_sub_f32 v16, v40, v44
    v_sub_f32 v17, v41, v45
    v_sub_f32 v12, v42, v47
    v_add_f32 v13, v43, v46
    v_add_f32 v20, v42, v47
    v_sub_f32 v21, v43, v46
    v_add_f32 v40, v32, v36
    v_add_f32 v41, v33, v37
    v_sub_f32 v42, v32, v36
    v_sub_f32 v43, v33, v37
    v_add_f32 v44, v34, v38
    v_add_f32 v45, v35, v39
    v_sub_f32 v46, v34, v38
    v_sub_f32 v47, v35, v39
    v_add_f32 v10, v40, v44
    v_add_f32 v11, v41, v45
    v_sub_f32 v18, v40, v44
    v_sub_f32 v19, v41, v45
    v_sub_f32 v14, v42, v47
    v_add_f32 v15, v43, v46
    v_add_f32 v22, v42, v47
    v_sub_f32 v23, v43, v46
    ds_write_b64 v107, v[8:9] offset:0
    ds_write_b64 v107, v[10:11] offset:32
    ds_write_b64 v107, v[12:13] offset:64
    ds_write_b64 v107, v[14:15] offset:96
    ds_write_b64 v107, v[16:17] offset:128
    ds_write_b64 v107, v[18:19] offset:160
    ds_write_b64 v107, v[20:21] offset:192
    ds_write_b64 v107, v[22:23] offset:224
    s_waitcnt lgkmcnt(0)
    s_barrier
    ds_read_b64 v[8:9], v106 offset:0
    ds_read_b64 v[10:11], v106 offset:2304
    ds_read_b64 v[12:13], v106 offset:4608
    ds_read_b64 v[14:15], v106 offset:6912
    ds_read_b64 v[16:17], v106 offset:9216
    ds_read_b64 v[18:19], v106 offset:11520
    ds_read_b64 v[20:21], v106 offset:13824
    ds_read_b64 v[22:23], v106 offset:16128
    s_waitcnt lgkmcnt(0)
    v_mul_f32 v116, v9, v65
    v_mul_f32 v117, v8, v65
    v_fma_f32 v8, v8, v64, v116
    v_fma_f32 v9, v9, v64, -v117
    v_mul_f32 v116, v11, v67
    v_mul_f32 v117, v10, v67
    v_fma_f32 v10, v10, v66, v116
    v_fma_f32 v11, v11, v66, -v117
    v_mul_f32 v116, v13, v69
    v_mul_f32 v117, v12, v69
    v_fma_f32 v12, v12, v68, v116
    v_fma_f32 v13, v13, v68, -v117
    v_mul_f32 v116, v15, v71
    v_mul_f32 v117, v14, v71
    v_fma_f32 v14, v14, v70, v116
    v_fma_f32 v15, v15, v70, -v117
    v_mul_f32 v116, v17, v73
    v_mul_f32 v117, v16, v73
    v_fma_f32 v16, v16, v72, v116
    v_fma_f32 v17, v17, v72, -v117
    v_mul_f32 v116, v19, v75
    v_mul_f32 v117, v18, v75
    v_fma_f32 v18, v18, v74, v116
    v_fma_f32 v19, v19, v74, -v117
    v_mul_f32 v116, v21, v77
    v_mul_f32 v117, v20, v77
    v_fma_f32 v20, v20, v76, v116
    v_fma_f32 v21, v21, v76, -v117
    v_mul_f32 v116, v23, v79
    v_mul_f32 v117, v22, v79
    v_fma_f32 v22, v22, v78, v116
    v_fma_f32 v23, v23, v78, -v117
    v_add_f32 v24, v8, v16
    v_add_f32 v25, v9, v17
    v_sub_f32 v32, v8, v16
    v_sub_f32 v33, v9, v17
    v_add_f32 v26, v10, v18
    v_add_f32 v27, v11, v19
    v_sub_f32 v34, v10, v18
    v_sub_f32 v35, v11, v19
    v_add_f32 v28, v12, v20
    v_add_f32 v29, v13, v21
    v_sub_f32 v36, v12, v20
    v_sub_f32 v37, v13, v21
    v_add_f32 v30, v14, v22
    v_add_f32 v31, v15, v23
    v_sub_f32 v38, v14, v22
    v_sub_f32 v39, v15, v23
    v_sub_f32 v40, v34, v35
    v_add_f32 v41, v34, v35
    v_mul_f32 v34, s36, v40
    v_mul_f32 v35, s36, v41
    v_add_f32 v40, v38, v39
    v_sub_f32 v41, v38, v39
    v_mul_f32 v38, s36, v40
    v_mul_f32 v39, s36, v41
    v_sub_f32 v38, 0, v38
    v_sub_f32 v40, 0, v37
    v_mov_b32 v37, v36
    v_mov_b32 v36, v40
    v_add_f32 v40, v24, v28
    v_add_f32 v41, v25, v29
    v_sub_f32 v42, v24, v28
    v_sub_f32 v43, v25, v29
    v_add_f32 v44, v26, v30
    v_add_f32 v45, v27, v31
    v_sub_f32 v46, v26, v30
    v_sub_f32 v47, v27, v31
    v_add_f32 v8, v40, v44
    v_add_f32 v9, v41, v45
    v_sub_f32 v16, v40, v44
    v_sub_f32 v17, v41, v45
    v_sub_f32 v12, v42, v47
    v_add_f32 v13, v43, v46
    v_add_f32 v20, v42, v47
    v_sub_f32 v21, v43, v46
    v_add_f32 v40, v32, v36
    v_add_f32 v41, v33, v37
    v_sub_f32 v42, v32, v36
    v_sub_f32 v43, v33, v37
    v_add_f32 v44, v34, v38
    v_add_f32 v45, v35, v39
    v_sub_f32 v46, v34, v38
    v_sub_f32 v47, v35, v39
    v_add_f32 v10, v40, v44
    v_add_f32 v11, v41, v45
    v_sub_f32 v18, v40, v44
    v_sub_f32 v19, v41, v45
    v_sub_f32 v14, v42, v47
    v_add_f32 v15, v43, v46
    v_add_f32 v22, v42, v47
    v_sub_f32 v23, v43, v46
    ds_write_b64 v105, v[8:9] offset:18432
    ds_write_b64 v105, v[10:11] offset:18688
    ds_write_b64 v105, v[12:13] offset:18944
    ds_write_b64 v105, v[14:15] offset:19200
    ds_write_b64 v105, v[16:17] offset:19456
    ds_write_b64 v105, v[18:19] offset:19712
    ds_write_b64 v105, v[20:21] offset:19968
    ds_write_b64 v105, v[22:23] offset:20224
    s_waitcnt lgkmcnt(0)
    s_barrier
    ds_read_b64 v[8:9], v104 offset:18432
    ds_read_b64 v[10:11], v104 offset:20480
    ds_read_b64 v[12:13], v104 offset:22528
    ds_read_b64 v[14:15], v104 offset:24576
    ds_read_b64 v[16:17], v104 offset:26624
    ds_read_b64 v[18:19], v104 offset:28672
    ds_read_b64 v[20:21], v104 offset:30720
    ds_read_b64 v[22:23], v104 offset:32768
    s_waitcnt lgkmcnt(0)
    v_mul_f32 v116, v11, v51
    v_mul_f32 v117, v10, v51
    v_fma_f32 v10, v10, v50, v116
    v_fma_f32 v11, v11, v50, -v117
    v_mul_f32 v116, v13, v53
    v_mul_f32 v117, v12, v53
    v_fma_f32 v12, v12, v52, v116
    v_fma_f32 v13, v13, v52, -v117
    v_mul_f32 v116, v15, v55
    v_mul_f32 v117, v14, v55
    v_fma_f32 v14, v14, v54, v116
    v_fma_f32 v15, v15, v54, -v117
    v_mul_f32 v116, v17, v57
    v_mul_f32 v117, v16, v57
    v_fma_f32 v16, v16, v56, v116
    v_fma_f32 v17, v17, v56, -v117
    v_mul_f32 v116, v19, v59
    v_mul_f32 v117, v18, v59
    v_fma_f32 v18, v18, v58, v116
    v_fma_f32 v19, v19, v58, -v117
    v_mul_f32 v116, v21, v61
    v_mul_f32 v117, v20, v61
    v_fma_f32 v20, v20, v60, v116
    v_fma_f32 v21, v21, v60, -v117
    v_mul_f32 v116, v23, v63
    v_mul_f32 v117, v22, v63
    v_fma_f32 v22, v22, v62, v116
    v_fma_f32 v23, v23, v62, -v117
    v_add_f32 v24, v8, v16
    v_add_f32 v25, v9, v17
    v_sub_f32 v32, v8, v16
    v_sub_f32 v33, v9, v17
    v_add_f32 v26, v10, v18
    v_add_f32 v27, v11, v19
    v_sub_f32 v34, v10, v18
    v_sub_f32 v35, v11, v19
    v_add_f32 v28, v12, v20
    v_add_f32 v29, v13, v21
    v_sub_f32 v36, v12, v20
    v_sub_f32 v37, v13, v21
    v_add_f32 v30, v14, v22
    v_add_f32 v31, v15, v23
    v_sub_f32 v38, v14, v22
    v_sub_f32 v39, v15, v23
    v_sub_f32 v40, v34, v35
    v_add_f32 v41, v34, v35
    v_mul_f32 v34, s36, v40
    v_mul_f32 v35, s36, v41
    v_add_f32 v40, v38, v39
    v_sub_f32 v41, v38, v39
    v_mul_f32 v38, s36, v40
    v_mul_f32 v39, s36, v41
    v_sub_f32 v38, 0, v38
    v_sub_f32 v40, 0, v37
    v_mov_b32 v37, v36
    v_mov_b32 v36, v40
    v_add_f32 v40, v24, v28
    v_add_f32 v41, v25, v29
    v_sub_f32 v42, v24, v28
    v_sub_f32 v43, v25, v29
    v_add_f32 v44, v26, v30
    v_add_f32 v45, v27, v31
    v_sub_f32 v46, v26, v30
    v_sub_f32 v47, v27, v31
    v_add_f32 v8, v40, v44
    v_add_f32 v9, v41, v45
    v_sub_f32 v16, v40, v44
    v_sub_f32 v17, v41, v45
    v_sub_f32 v12, v42, v47
    v_add_f32 v13, v43, v46
    v_add_f32 v20, v42, v47
    v_sub_f32 v21, v43, v46
    v_add_f32 v40, v32, v36
    v_add_f32 v41, v33, v37
    v_sub_f32 v42, v32, v36
    v_sub_f32 v43, v33, v37
    v_add_f32 v44, v34, v38
    v_add_f32 v45, v35, v39
    v_sub_f32 v46, v34, v38
    v_sub_f32 v47, v35, v39
    v_add_f32 v10, v40, v44
    v_add_f32 v11, v41, v45
    v_sub_f32 v18, v40, v44
    v_sub_f32 v19, v41, v45
    v_sub_f32 v14, v42, v47
    v_add_f32 v15, v43, v46
    v_add_f32 v22, v42, v47
    v_sub_f32 v23, v43, v46
    buffer_store_dwordx2 v[8:9], v104, s[24:27], s40 offen offset:0
    buffer_store_dwordx2 v[10:11], v104, s[24:27], s40 offen offset:2048
    buffer_store_dwordx2 v[12:13], v104, s[24:27], s41 offen offset:0
    buffer_store_dwordx2 v[14:15], v104, s[24:27], s41 offen offset:2048
    buffer_store_dwordx2 v[16:17], v104, s[24:27], s42 offen offset:0
    buffer_store_dwordx2 v[18:19], v104, s[24:27], s42 offen offset:2048
    buffer_store_dwordx2 v[20:21], v104, s[24:27], s43 offen offset:0
    buffer_store_dwordx2 v[22:23], v104, s[24:27], s43 offen offset:2048
    s_waitcnt lgkmcnt(0)
    s_endpgm

.globl final_kernel
.p2align 8
.type final_kernel,@function
final_kernel:
    s_cmp_ge_u32 s2, 256
    s_cbranch_scc1 L_fin_done
    s_load_dwordx2 s[4:5], s[0:1], 0
    s_load_dwordx2 s[6:7], s[0:1], 56
    s_load_dwordx2 s[10:11], s[0:1], 72
    v_and_b32 v1, 63, v0
    v_lshrrev_b32 v2, 6, v0
    s_lshl_b32 s40, s2, 3
    v_lshlrev_b32 v3, 1, v2
    v_add_u32 v3, s40, v3
    v_lshlrev_b32 v4, 10, v3
    v_lshl_add_u32 v4, v1, 1, v4
    v_lshlrev_b32 v5, 14, v1
    v_lshl_add_u32 v5, v3, 3, v5
    v_sub_u32 v6, 64, v1
    v_lshlrev_b32 v6, 14, v6
    v_lshl_add_u32 v6, v3, 3, v6
    s_mov_b32 s36, 0x3f3504f3
    s_mov_b32 s44, 0x0
    s_mov_b32 s45, 0x100000
    s_mov_b32 s46, 0x200000
    s_mov_b32 s47, 0x300000
    s_waitcnt lgkmcnt(0)
    s_mov_b32 s12, s4
    s_mov_b32 s13, s5
    s_mov_b32 s14, 0x200000
    s_mov_b32 s15, 0x00020000
    s_mov_b32 s16, s6
    s_mov_b32 s17, s7
    s_mov_b32 s18, 0x200000
    s_mov_b32 s19, 0x00020000
    s_mov_b32 s24, s10
    s_mov_b32 s25, s11
    s_mov_b32 s26, 0x404000
    s_mov_b32 s27, 0x00020000
    s_add_u32 s32, s10, 0x1200000
    s_addc_u32 s33, s11, 0
    s_mov_b32 s34, 0x200000
    s_mov_b32 s35, 0x00020000
    buffer_load_dwordx4 v[24:27], v5, s[24:27], s44 offen
    buffer_load_dwordx4 v[28:31], v5, s[24:27], s45 offen
    buffer_load_dwordx4 v[32:35], v5, s[24:27], s46 offen
    buffer_load_dwordx4 v[36:39], v5, s[24:27], s47 offen
    buffer_load_dwordx4 v[40:43], v6, s[24:27], s47 offen
    buffer_load_dwordx4 v[44:47], v6, s[24:27], s46 offen
    buffer_load_dwordx4 v[48:51], v6, s[24:27], s45 offen
    buffer_load_dwordx4 v[52:55], v6, s[24:27], s44 offen
    buffer_load_ushort v132, v4, s[12:15], 0 offen offset:0
    buffer_load_ushort v133, v4, s[12:15], 0 offen offset:1024
    buffer_load_ushort v134, v4, s[12:15], 0 offen offset:128
    buffer_load_ushort v135, v4, s[12:15], 0 offen offset:1152
    buffer_load_ushort v136, v4, s[12:15], 0 offen offset:256
    buffer_load_ushort v137, v4, s[12:15], 0 offen offset:1280
    buffer_load_ushort v138, v4, s[12:15], 0 offen offset:384
    buffer_load_ushort v139, v4, s[12:15], 0 offen offset:1408
    buffer_load_ushort v140, v4, s[12:15], 0 offen offset:512
    buffer_load_ushort v141, v4, s[12:15], 0 offen offset:1536
    buffer_load_ushort v142, v4, s[12:15], 0 offen offset:640
    buffer_load_ushort v143, v4, s[12:15], 0 offen offset:1664
    buffer_load_ushort v144, v4, s[12:15], 0 offen offset:768
    buffer_load_ushort v145, v4, s[12:15], 0 offen offset:1792
    buffer_load_ushort v146, v4, s[12:15], 0 offen offset:896
    buffer_load_ushort v147, v4, s[12:15], 0 offen offset:1920
    buffer_load_ushort v148, v4, s[32:35], 0 offen offset:0
    buffer_load_ushort v149, v4, s[32:35], 0 offen offset:1024
    buffer_load_ushort v150, v4, s[32:35], 0 offen offset:128
    buffer_load_ushort v151, v4, s[32:35], 0 offen offset:1152
    buffer_load_ushort v152, v4, s[32:35], 0 offen offset:256
    buffer_load_ushort v153, v4, s[32:35], 0 offen offset:1280
    buffer_load_ushort v154, v4, s[32:35], 0 offen offset:384
    buffer_load_ushort v155, v4, s[32:35], 0 offen offset:1408
    buffer_load_ushort v156, v4, s[32:35], 0 offen offset:512
    buffer_load_ushort v157, v4, s[32:35], 0 offen offset:1536
    buffer_load_ushort v158, v4, s[32:35], 0 offen offset:640
    buffer_load_ushort v159, v4, s[32:35], 0 offen offset:1664
    buffer_load_ushort v160, v4, s[32:35], 0 offen offset:768
    buffer_load_ushort v161, v4, s[32:35], 0 offen offset:1792
    buffer_load_ushort v162, v4, s[32:35], 0 offen offset:896
    buffer_load_ushort v163, v4, s[32:35], 0 offen offset:1920
    v_lshrrev_b32 v100, 3, v1
    v_cvt_f32_u32 v100, v100
    v_mul_f32 v100, 0xbc800000, v100
    v_mul_f32 v101, 0x3f800000, v100
    v_cos_f32 v70, v101
    v_sin_f32 v71, v101
    v_mul_f32 v101, 0x40000000, v100
    v_cos_f32 v72, v101
    v_sin_f32 v73, v101
    v_mul_f32 v101, 0x40400000, v100
    v_cos_f32 v74, v101
    v_sin_f32 v75, v101
    v_mul_f32 v101, 0x40800000, v100
    v_cos_f32 v76, v101
    v_sin_f32 v77, v101
    v_mul_f32 v101, 0x40a00000, v100
    v_cos_f32 v78, v101
    v_sin_f32 v79, v101
    v_mul_f32 v101, 0x40c00000, v100
    v_cos_f32 v80, v101
    v_sin_f32 v81, v101
    v_mul_f32 v101, 0x40e00000, v100
    v_cos_f32 v82, v101
    v_sin_f32 v83, v101
    v_and_b32 v100, 7, v1
    v_lshrrev_b32 v101, 3, v1
    v_mul_u32_u24 v102, v100, v101
    v_cvt_f32_u32 v102, v102
    v_cvt_f32_u32 v100, v100
    v_mul_f32 v102, 0xbb000000, v102
    v_mul_f32 v100, 0xbc800000, v100
    v_mov_b32 v103, 0x0
    v_fma_f32 v101, v100, v103, v102
    v_cos_f32 v84, v101
    v_sin_f32 v85, v101
    v_mov_b32 v103, 0x3f800000
    v_fma_f32 v101, v100, v103, v102
    v_cos_f32 v86, v101
    v_sin_f32 v87, v101
    v_mov_b32 v103, 0x40000000
    v_fma_f32 v101, v100, v103, v102
    v_cos_f32 v88, v101
    v_sin_f32 v89, v101
    v_mov_b32 v103, 0x40400000
    v_fma_f32 v101, v100, v103, v102
    v_cos_f32 v90, v101
    v_sin_f32 v91, v101
    v_mov_b32 v103, 0x40800000
    v_fma_f32 v101, v100, v103, v102
    v_cos_f32 v92, v101
    v_sin_f32 v93, v101
    v_mov_b32 v103, 0x40a00000
    v_fma_f32 v101, v100, v103, v102
    v_cos_f32 v94, v101
    v_sin_f32 v95, v101
    v_mov_b32 v103, 0x40c00000
    v_fma_f32 v101, v100, v103, v102
    v_cos_f32 v96, v101
    v_sin_f32 v97, v101
    v_mov_b32 v103, 0x40e00000
    v_fma_f32 v101, v100, v103, v102
    v_cos_f32 v98, v101
    v_sin_f32 v99, v101
    v_mul_u32_u24 v125, 5120, v2
    v_lshl_add_u32 v120, v1, 3, v125
    v_lshrrev_b32 v126, 3, v1
    v_and_b32 v127, 7, v1
    v_mul_u32_u24 v128, 72, v126
    v_add_u32 v128, v128, v127
    v_lshl_add_u32 v121, v128, 3, v125
    v_mul_u32_u24 v128, 9, v126
    v_add_u32 v128, v128, v127
    v_lshl_add_u32 v122, v128, 3, v125
    v_mul_u32_u24 v128, 72, v126
    v_mul_u32_u24 v129, 9, v127
    v_add_u32 v128, v128, v129
    v_lshl_add_u32 v123, v128, 3, v125
    v_cmp_eq_u32 vcc, 0, v1
    v_mov_b32 v129, 0
    s_waitcnt vmcnt(32)
    v_cndmask_b32 v25, v25, v129, vcc
    v_cndmask_b32 v27, v27, v129, vcc
    v_cndmask_b32 v41, v41, v129, vcc
    v_cndmask_b32 v43, v43, v129, vcc
    v_sub_f32 v8, v24, v27
    v_add_f32 v9, v25, v26
    v_sub_f32 v10, v28, v31
    v_add_f32 v11, v29, v30
    v_sub_f32 v12, v32, v35
    v_add_f32 v13, v33, v34
    v_sub_f32 v14, v36, v39
    v_add_f32 v15, v37, v38
    v_add_f32 v16, v40, v43
    v_sub_f32 v17, v42, v41
    v_add_f32 v18, v44, v47
    v_sub_f32 v19, v46, v45
    v_add_f32 v20, v48, v51
    v_sub_f32 v21, v50, v49
    v_add_f32 v22, v52, v55
    v_sub_f32 v23, v54, v53
    v_add_f32 v24, v8, v16
    v_add_f32 v25, v9, v17
    v_sub_f32 v32, v8, v16
    v_sub_f32 v33, v9, v17
    v_add_f32 v26, v10, v18
    v_add_f32 v27, v11, v19
    v_sub_f32 v34, v10, v18
    v_sub_f32 v35, v11, v19
    v_add_f32 v28, v12, v20
    v_add_f32 v29, v13, v21
    v_sub_f32 v36, v12, v20
    v_sub_f32 v37, v13, v21
    v_add_f32 v30, v14, v22
    v_add_f32 v31, v15, v23
    v_sub_f32 v38, v14, v22
    v_sub_f32 v39, v15, v23
    v_sub_f32 v40, v34, v35
    v_add_f32 v41, v34, v35
    v_mul_f32 v34, s36, v40
    v_mul_f32 v35, s36, v41
    v_add_f32 v40, v38, v39
    v_sub_f32 v41, v38, v39
    v_mul_f32 v38, s36, v40
    v_mul_f32 v39, s36, v41
    v_sub_f32 v38, 0, v38
    v_sub_f32 v40, 0, v37
    v_mov_b32 v37, v36
    v_mov_b32 v36, v40
    v_add_f32 v40, v24, v28
    v_add_f32 v41, v25, v29
    v_sub_f32 v42, v24, v28
    v_sub_f32 v43, v25, v29
    v_add_f32 v44, v26, v30
    v_add_f32 v45, v27, v31
    v_sub_f32 v46, v26, v30
    v_sub_f32 v47, v27, v31
    v_add_f32 v8, v40, v44
    v_add_f32 v9, v41, v45
    v_sub_f32 v16, v40, v44
    v_sub_f32 v17, v41, v45
    v_sub_f32 v12, v42, v47
    v_add_f32 v13, v43, v46
    v_add_f32 v20, v42, v47
    v_sub_f32 v21, v43, v46
    v_add_f32 v40, v32, v36
    v_add_f32 v41, v33, v37
    v_sub_f32 v42, v32, v36
    v_sub_f32 v43, v33, v37
    v_add_f32 v44, v34, v38
    v_add_f32 v45, v35, v39
    v_sub_f32 v46, v34, v38
    v_sub_f32 v47, v35, v39
    v_add_f32 v10, v40, v44
    v_add_f32 v11, v41, v45
    v_sub_f32 v18, v40, v44
    v_sub_f32 v19, v41, v45
    v_sub_f32 v14, v42, v47
    v_add_f32 v15, v43, v46
    v_add_f32 v22, v42, v47
    v_sub_f32 v23, v43, v46
    ds_write_b64 v123, v[8:9] offset:0
    ds_write_b64 v123, v[10:11] offset:8
    ds_write_b64 v123, v[12:13] offset:16
    ds_write_b64 v123, v[14:15] offset:24
    ds_write_b64 v123, v[16:17] offset:32
    ds_write_b64 v123, v[18:19] offset:40
    ds_write_b64 v123, v[20:21] offset:48
    ds_write_b64 v123, v[22:23] offset:56
    s_waitcnt lgkmcnt(0)
    ds_read_b64 v[8:9], v122 offset:0
    ds_read_b64 v[10:11], v122 offset:576
    ds_read_b64 v[12:13], v122 offset:1152
    ds_read_b64 v[14:15], v122 offset:1728
    ds_read_b64 v[16:17], v122 offset:2304
    ds_read_b64 v[18:19], v122 offset:2880
    ds_read_b64 v[20:21], v122 offset:3456
    ds_read_b64 v[22:23], v122 offset:4032
    s_waitcnt lgkmcnt(0)
    v_mul_f32 v104, v9, v85
    v_mul_f32 v105, v8, v85
    v_fma_f32 v8, v8, v84, v104
    v_fma_f32 v9, v9, v84, -v105
    v_mul_f32 v104, v11, v87
    v_mul_f32 v105, v10, v87
    v_fma_f32 v10, v10, v86, v104
    v_fma_f32 v11, v11, v86, -v105
    v_mul_f32 v104, v13, v89
    v_mul_f32 v105, v12, v89
    v_fma_f32 v12, v12, v88, v104
    v_fma_f32 v13, v13, v88, -v105
    v_mul_f32 v104, v15, v91
    v_mul_f32 v105, v14, v91
    v_fma_f32 v14, v14, v90, v104
    v_fma_f32 v15, v15, v90, -v105
    v_mul_f32 v104, v17, v93
    v_mul_f32 v105, v16, v93
    v_fma_f32 v16, v16, v92, v104
    v_fma_f32 v17, v17, v92, -v105
    v_mul_f32 v104, v19, v95
    v_mul_f32 v105, v18, v95
    v_fma_f32 v18, v18, v94, v104
    v_fma_f32 v19, v19, v94, -v105
    v_mul_f32 v104, v21, v97
    v_mul_f32 v105, v20, v97
    v_fma_f32 v20, v20, v96, v104
    v_fma_f32 v21, v21, v96, -v105
    v_mul_f32 v104, v23, v99
    v_mul_f32 v105, v22, v99
    v_fma_f32 v22, v22, v98, v104
    v_fma_f32 v23, v23, v98, -v105
    v_add_f32 v24, v8, v16
    v_add_f32 v25, v9, v17
    v_sub_f32 v32, v8, v16
    v_sub_f32 v33, v9, v17
    v_add_f32 v26, v10, v18
    v_add_f32 v27, v11, v19
    v_sub_f32 v34, v10, v18
    v_sub_f32 v35, v11, v19
    v_add_f32 v28, v12, v20
    v_add_f32 v29, v13, v21
    v_sub_f32 v36, v12, v20
    v_sub_f32 v37, v13, v21
    v_add_f32 v30, v14, v22
    v_add_f32 v31, v15, v23
    v_sub_f32 v38, v14, v22
    v_sub_f32 v39, v15, v23
    v_sub_f32 v40, v34, v35
    v_add_f32 v41, v34, v35
    v_mul_f32 v34, s36, v40
    v_mul_f32 v35, s36, v41
    v_add_f32 v40, v38, v39
    v_sub_f32 v41, v38, v39
    v_mul_f32 v38, s36, v40
    v_mul_f32 v39, s36, v41
    v_sub_f32 v38, 0, v38
    v_sub_f32 v40, 0, v37
    v_mov_b32 v37, v36
    v_mov_b32 v36, v40
    v_add_f32 v40, v24, v28
    v_add_f32 v41, v25, v29
    v_sub_f32 v42, v24, v28
    v_sub_f32 v43, v25, v29
    v_add_f32 v44, v26, v30
    v_add_f32 v45, v27, v31
    v_sub_f32 v46, v26, v30
    v_sub_f32 v47, v27, v31
    v_add_f32 v8, v40, v44
    v_add_f32 v9, v41, v45
    v_sub_f32 v16, v40, v44
    v_sub_f32 v17, v41, v45
    v_sub_f32 v12, v42, v47
    v_add_f32 v13, v43, v46
    v_add_f32 v20, v42, v47
    v_sub_f32 v21, v43, v46
    v_add_f32 v40, v32, v36
    v_add_f32 v41, v33, v37
    v_sub_f32 v42, v32, v36
    v_sub_f32 v43, v33, v37
    v_add_f32 v44, v34, v38
    v_add_f32 v45, v35, v39
    v_sub_f32 v46, v34, v38
    v_sub_f32 v47, v35, v39
    v_add_f32 v10, v40, v44
    v_add_f32 v11, v41, v45
    v_sub_f32 v18, v40, v44
    v_sub_f32 v19, v41, v45
    v_sub_f32 v14, v42, v47
    v_add_f32 v15, v43, v46
    v_add_f32 v22, v42, v47
    v_sub_f32 v23, v43, v46
    ds_write_b64 v121, v[8:9] offset:0
    ds_write_b64 v121, v[10:11] offset:64
    ds_write_b64 v121, v[12:13] offset:128
    ds_write_b64 v121, v[14:15] offset:192
    ds_write_b64 v121, v[16:17] offset:256
    ds_write_b64 v121, v[18:19] offset:320
    ds_write_b64 v121, v[20:21] offset:384
    ds_write_b64 v121, v[22:23] offset:448
    s_waitcnt lgkmcnt(0)
    ds_read_b64 v[8:9], v120 offset:0
    ds_read_b64 v[10:11], v120 offset:576
    ds_read_b64 v[12:13], v120 offset:1152
    ds_read_b64 v[14:15], v120 offset:1728
    ds_read_b64 v[16:17], v120 offset:2304
    ds_read_b64 v[18:19], v120 offset:2880
    ds_read_b64 v[20:21], v120 offset:3456
    ds_read_b64 v[22:23], v120 offset:4032
    s_waitcnt lgkmcnt(0)
    v_mul_f32 v104, v11, v71
    v_mul_f32 v105, v10, v71
    v_fma_f32 v10, v10, v70, v104
    v_fma_f32 v11, v11, v70, -v105
    v_mul_f32 v104, v13, v73
    v_mul_f32 v105, v12, v73
    v_fma_f32 v12, v12, v72, v104
    v_fma_f32 v13, v13, v72, -v105
    v_mul_f32 v104, v15, v75
    v_mul_f32 v105, v14, v75
    v_fma_f32 v14, v14, v74, v104
    v_fma_f32 v15, v15, v74, -v105
    v_mul_f32 v104, v17, v77
    v_mul_f32 v105, v16, v77
    v_fma_f32 v16, v16, v76, v104
    v_fma_f32 v17, v17, v76, -v105
    v_mul_f32 v104, v19, v79
    v_mul_f32 v105, v18, v79
    v_fma_f32 v18, v18, v78, v104
    v_fma_f32 v19, v19, v78, -v105
    v_mul_f32 v104, v21, v81
    v_mul_f32 v105, v20, v81
    v_fma_f32 v20, v20, v80, v104
    v_fma_f32 v21, v21, v80, -v105
    v_mul_f32 v104, v23, v83
    v_mul_f32 v105, v22, v83
    v_fma_f32 v22, v22, v82, v104
    v_fma_f32 v23, v23, v82, -v105
    v_add_f32 v24, v8, v16
    v_add_f32 v25, v9, v17
    v_sub_f32 v32, v8, v16
    v_sub_f32 v33, v9, v17
    v_add_f32 v26, v10, v18
    v_add_f32 v27, v11, v19
    v_sub_f32 v34, v10, v18
    v_sub_f32 v35, v11, v19
    v_add_f32 v28, v12, v20
    v_add_f32 v29, v13, v21
    v_sub_f32 v36, v12, v20
    v_sub_f32 v37, v13, v21
    v_add_f32 v30, v14, v22
    v_add_f32 v31, v15, v23
    v_sub_f32 v38, v14, v22
    v_sub_f32 v39, v15, v23
    v_sub_f32 v40, v34, v35
    v_add_f32 v41, v34, v35
    v_mul_f32 v34, s36, v40
    v_mul_f32 v35, s36, v41
    v_add_f32 v40, v38, v39
    v_sub_f32 v41, v38, v39
    v_mul_f32 v38, s36, v40
    v_mul_f32 v39, s36, v41
    v_sub_f32 v38, 0, v38
    v_sub_f32 v40, 0, v37
    v_mov_b32 v37, v36
    v_mov_b32 v36, v40
    v_add_f32 v40, v24, v28
    v_add_f32 v41, v25, v29
    v_sub_f32 v42, v24, v28
    v_sub_f32 v43, v25, v29
    v_add_f32 v44, v26, v30
    v_add_f32 v45, v27, v31
    v_sub_f32 v46, v26, v30
    v_sub_f32 v47, v27, v31
    v_add_f32 v8, v40, v44
    v_add_f32 v9, v41, v45
    v_sub_f32 v16, v40, v44
    v_sub_f32 v17, v41, v45
    v_sub_f32 v12, v42, v47
    v_add_f32 v13, v43, v46
    v_add_f32 v20, v42, v47
    v_sub_f32 v21, v43, v46
    v_add_f32 v40, v32, v36
    v_add_f32 v41, v33, v37
    v_sub_f32 v42, v32, v36
    v_sub_f32 v43, v33, v37
    v_add_f32 v44, v34, v38
    v_add_f32 v45, v35, v39
    v_sub_f32 v46, v34, v38
    v_sub_f32 v47, v35, v39
    v_add_f32 v10, v40, v44
    v_add_f32 v11, v41, v45
    v_sub_f32 v18, v40, v44
    v_sub_f32 v19, v41, v45
    v_sub_f32 v14, v42, v47
    v_add_f32 v15, v43, v46
    v_add_f32 v22, v42, v47
    v_sub_f32 v23, v43, v46
    s_waitcnt vmcnt(0)
    v_lshlrev_b32 v132, 16, v132
    v_lshlrev_b32 v148, 16, v148
    v_lshlrev_b32 v133, 16, v133
    v_lshlrev_b32 v149, 16, v149
    v_cvt_pk_bf16_f32 v100, v8, v9
    v_lshlrev_b32 v8, 16, v100
    v_and_b32 v9, 0xffff0000, v100
    v_mul_f32 v8, v8, v148
    v_mul_f32 v9, v9, v149
    v_cvt_pk_bf16_f32 v100, v8, v9
    v_lshlrev_b32 v8, 16, v100
    v_and_b32 v9, 0xffff0000, v100
    v_add_f32 v8, v8, v132
    v_add_f32 v9, v9, v133
    v_cvt_pk_bf16_f32 v8, v8, v9
    buffer_store_short v8, v4, s[16:19], 0 offen offset:0
    buffer_store_short_d16_hi v8, v4, s[16:19], 0 offen offset:1024
    v_lshlrev_b32 v134, 16, v134
    v_lshlrev_b32 v150, 16, v150
    v_lshlrev_b32 v135, 16, v135
    v_lshlrev_b32 v151, 16, v151
    v_cvt_pk_bf16_f32 v100, v10, v11
    v_lshlrev_b32 v10, 16, v100
    v_and_b32 v11, 0xffff0000, v100
    v_mul_f32 v10, v10, v150
    v_mul_f32 v11, v11, v151
    v_cvt_pk_bf16_f32 v100, v10, v11
    v_lshlrev_b32 v10, 16, v100
    v_and_b32 v11, 0xffff0000, v100
    v_add_f32 v10, v10, v134
    v_add_f32 v11, v11, v135
    v_cvt_pk_bf16_f32 v10, v10, v11
    buffer_store_short v10, v4, s[16:19], 0 offen offset:128
    buffer_store_short_d16_hi v10, v4, s[16:19], 0 offen offset:1152
    v_lshlrev_b32 v136, 16, v136
    v_lshlrev_b32 v152, 16, v152
    v_lshlrev_b32 v137, 16, v137
    v_lshlrev_b32 v153, 16, v153
    v_cvt_pk_bf16_f32 v100, v12, v13
    v_lshlrev_b32 v12, 16, v100
    v_and_b32 v13, 0xffff0000, v100
    v_mul_f32 v12, v12, v152
    v_mul_f32 v13, v13, v153
    v_cvt_pk_bf16_f32 v100, v12, v13
    v_lshlrev_b32 v12, 16, v100
    v_and_b32 v13, 0xffff0000, v100
    v_add_f32 v12, v12, v136
    v_add_f32 v13, v13, v137
    v_cvt_pk_bf16_f32 v12, v12, v13
    buffer_store_short v12, v4, s[16:19], 0 offen offset:256
    buffer_store_short_d16_hi v12, v4, s[16:19], 0 offen offset:1280
    v_lshlrev_b32 v138, 16, v138
    v_lshlrev_b32 v154, 16, v154
    v_lshlrev_b32 v139, 16, v139
    v_lshlrev_b32 v155, 16, v155
    v_cvt_pk_bf16_f32 v100, v14, v15
    v_lshlrev_b32 v14, 16, v100
    v_and_b32 v15, 0xffff0000, v100
    v_mul_f32 v14, v14, v154
    v_mul_f32 v15, v15, v155
    v_cvt_pk_bf16_f32 v100, v14, v15
    v_lshlrev_b32 v14, 16, v100
    v_and_b32 v15, 0xffff0000, v100
    v_add_f32 v14, v14, v138
    v_add_f32 v15, v15, v139
    v_cvt_pk_bf16_f32 v14, v14, v15
    buffer_store_short v14, v4, s[16:19], 0 offen offset:384
    buffer_store_short_d16_hi v14, v4, s[16:19], 0 offen offset:1408
    v_lshlrev_b32 v140, 16, v140
    v_lshlrev_b32 v156, 16, v156
    v_lshlrev_b32 v141, 16, v141
    v_lshlrev_b32 v157, 16, v157
    v_cvt_pk_bf16_f32 v100, v16, v17
    v_lshlrev_b32 v16, 16, v100
    v_and_b32 v17, 0xffff0000, v100
    v_mul_f32 v16, v16, v156
    v_mul_f32 v17, v17, v157
    v_cvt_pk_bf16_f32 v100, v16, v17
    v_lshlrev_b32 v16, 16, v100
    v_and_b32 v17, 0xffff0000, v100
    v_add_f32 v16, v16, v140
    v_add_f32 v17, v17, v141
    v_cvt_pk_bf16_f32 v16, v16, v17
    buffer_store_short v16, v4, s[16:19], 0 offen offset:512
    buffer_store_short_d16_hi v16, v4, s[16:19], 0 offen offset:1536
    v_lshlrev_b32 v142, 16, v142
    v_lshlrev_b32 v158, 16, v158
    v_lshlrev_b32 v143, 16, v143
    v_lshlrev_b32 v159, 16, v159
    v_cvt_pk_bf16_f32 v100, v18, v19
    v_lshlrev_b32 v18, 16, v100
    v_and_b32 v19, 0xffff0000, v100
    v_mul_f32 v18, v18, v158
    v_mul_f32 v19, v19, v159
    v_cvt_pk_bf16_f32 v100, v18, v19
    v_lshlrev_b32 v18, 16, v100
    v_and_b32 v19, 0xffff0000, v100
    v_add_f32 v18, v18, v142
    v_add_f32 v19, v19, v143
    v_cvt_pk_bf16_f32 v18, v18, v19
    buffer_store_short v18, v4, s[16:19], 0 offen offset:640
    buffer_store_short_d16_hi v18, v4, s[16:19], 0 offen offset:1664
    v_lshlrev_b32 v144, 16, v144
    v_lshlrev_b32 v160, 16, v160
    v_lshlrev_b32 v145, 16, v145
    v_lshlrev_b32 v161, 16, v161
    v_cvt_pk_bf16_f32 v100, v20, v21
    v_lshlrev_b32 v20, 16, v100
    v_and_b32 v21, 0xffff0000, v100
    v_mul_f32 v20, v20, v160
    v_mul_f32 v21, v21, v161
    v_cvt_pk_bf16_f32 v100, v20, v21
    v_lshlrev_b32 v20, 16, v100
    v_and_b32 v21, 0xffff0000, v100
    v_add_f32 v20, v20, v144
    v_add_f32 v21, v21, v145
    v_cvt_pk_bf16_f32 v20, v20, v21
    buffer_store_short v20, v4, s[16:19], 0 offen offset:768
    buffer_store_short_d16_hi v20, v4, s[16:19], 0 offen offset:1792
    v_lshlrev_b32 v146, 16, v146
    v_lshlrev_b32 v162, 16, v162
    v_lshlrev_b32 v147, 16, v147
    v_lshlrev_b32 v163, 16, v163
    v_cvt_pk_bf16_f32 v100, v22, v23
    v_lshlrev_b32 v22, 16, v100
    v_and_b32 v23, 0xffff0000, v100
    v_mul_f32 v22, v22, v162
    v_mul_f32 v23, v23, v163
    v_cvt_pk_bf16_f32 v100, v22, v23
    v_lshlrev_b32 v22, 16, v100
    v_and_b32 v23, 0xffff0000, v100
    v_add_f32 v22, v22, v146
    v_add_f32 v23, v23, v147
    v_cvt_pk_bf16_f32 v22, v22, v23
    buffer_store_short v22, v4, s[16:19], 0 offen offset:896
    buffer_store_short_d16_hi v22, v4, s[16:19], 0 offen offset:1920
L_fin_done:
    s_endpgm
.section .rodata,"a"
.p2align 6
.amdhsa_kernel rows_kernel
  .amdhsa_next_free_vgpr 132
  .amdhsa_next_free_sgpr 100
  .amdhsa_accum_offset 132
  .amdhsa_group_segment_fixed_size 0
  .amdhsa_kernarg_size 80
  .amdhsa_user_sgpr_count 2
  .amdhsa_user_sgpr_kernarg_segment_ptr 1
  .amdhsa_system_sgpr_workgroup_id_x 1
.end_amdhsa_kernel

.p2align 6
.amdhsa_kernel gemm1_kernel
  .amdhsa_next_free_vgpr 256
  .amdhsa_next_free_sgpr 100
  .amdhsa_accum_offset 256
  .amdhsa_group_segment_fixed_size 0
  .amdhsa_kernarg_size 80
  .amdhsa_user_sgpr_count 2
  .amdhsa_user_sgpr_kernarg_segment_ptr 1
  .amdhsa_system_sgpr_workgroup_id_x 1
.end_amdhsa_kernel

.p2align 6
.amdhsa_kernel gemm2_kernel
  .amdhsa_next_free_vgpr 256
  .amdhsa_next_free_sgpr 100
  .amdhsa_accum_offset 256
  .amdhsa_group_segment_fixed_size 0
  .amdhsa_kernarg_size 80
  .amdhsa_user_sgpr_count 2
  .amdhsa_user_sgpr_kernarg_segment_ptr 1
  .amdhsa_system_sgpr_workgroup_id_x 1
.end_amdhsa_kernel

.p2align 6
.amdhsa_kernel final_kernel
  .amdhsa_next_free_vgpr 164
  .amdhsa_next_free_sgpr 100
  .amdhsa_accum_offset 164
  .amdhsa_group_segment_fixed_size 0
  .amdhsa_kernarg_size 80
  .amdhsa_user_sgpr_count 2
  .amdhsa_user_sgpr_kernarg_segment_ptr 1
  .amdhsa_system_sgpr_workgroup_id_x 1
.end_amdhsa_kernel
```
